```python
import torch

def _softmax(x, axis=-1):
    return torch.softmax(x, dim=axis)
def _gelu(x):
    return torch.nn.functional.gelu(x, approximate="tanh")
def _silu(x):
    return torch.nn.functional.silu(x)
def _sigmoid(x):
    return torch.sigmoid(x)
def _layernorm(x, axis=-1, eps=1e-5):
    m = x.mean(dim=axis, keepdim=True)
    v = x.var(dim=axis, keepdim=True, unbiased=False)
    return (x - m) / torch.sqrt(v + eps)
def _scatter_add(tgt, idx, src, axis=0):
    return tgt.clone().index_add_(axis, idx, src)
def _segment_sum(src, seg, n):
    out = torch.zeros((n,) + src.shape[1:], dtype=src.dtype)
    return out.index_add_(0, seg, src)
def _pad(x, pw):
    flat = tuple(v for pair in reversed(pw) for v in pair)
    return torch.nn.functional.pad(x, flat)

kernel_name = 'standalone__seq2seq_rnn_t_joint__speech'

def setup_inputs():

    _w = (lambda a: (lambda t: t.to(torch.bfloat16) if t.is_floating_point() else t)(torch.as_tensor(a)))
    B, T, D, K = 2, 4000, 144, 15
    U = 8
    sc = (1.0 / (K * D)) ** 0.5
    sd = (1.0 / D) ** 0.5
    return {
        "x": _w((lambda *s: torch.randn(*s, dtype=torch.bfloat16) * 0.2)(B, T, D) * 0.5),
        "w1": _w((lambda *s: torch.randn(*s, dtype=torch.bfloat16) * 3.2)(K, D, D) * sc),
        "w2": _w((lambda *s: torch.randn(*s, dtype=torch.bfloat16) * 3.2)(K, D, D) * sc),
        "g": _w((lambda *s: torch.randn(*s, dtype=torch.bfloat16) * 3.2)(B, U, D) * 0.5),
        "w_f": _w((lambda *s: torch.randn(*s, dtype=torch.bfloat16) * 3.2)(D, D) * sd),
        "w_g": _w((lambda *s: torch.randn(*s, dtype=torch.bfloat16) * 3.2)(D, D) * sd),
        "w_o": _w((lambda *s: torch.randn(*s, dtype=torch.bfloat16) * 3.2)(D, D) * sd),
    }

def reference(x, w1, w2, g, w_f, w_g, w_o):
    B, T, D = x.shape
    K = w1.shape[0]
    pad = K // 2
    xp = _pad(x, ((0,0),(pad,pad),(0,0)))
    h = torch.zeros_like(x)
    for i in range(K):
        h = h + torch.einsum("btc,cd->btd", xp[:, i:i+T, :], w1[i])
    h = _gelu(h)[:, ::2, :]
    T1 = h.shape[1]
    hp = _pad(h, ((0,0),(pad,pad),(0,0)))
    f = torch.zeros_like(h)
    for i in range(K):
        f = f + torch.einsum("btc,cd->btd", hp[:, i:i+T1, :], w2[i])
    f = _gelu(f)[:, ::2, :]
    fe = torch.einsum("btd,de->bte", f, w_f)
    ge = torch.einsum("bud,de->bue", g, w_g)
    j = torch.tanh(fe[:, :, None, :] + ge[:, None, :, :])
    return torch.einsum("btud,dv->btuv", j, w_o)
```

```asm
; @launch grid=(252,1,1) block=(512,1,1) lds=162560
.amdgcn_target "amdgcn-amd-amdhsa--gfx950"
.text
.globl standalone__seq2seq_rnn_t_joint__speech_kernel
.p2align 8
.type standalone__seq2seq_rnn_t_joint__speech_kernel,@function
standalone__seq2seq_rnn_t_joint__speech_kernel:
    s_cmp_ge_u32 s2, 252
    s_cbranch_scc1 L_k1_end
    s_load_dwordx4 s[4:7], s[0:1], 0
    s_load_dwordx2 s[24:25], s[0:1], 16
    s_load_dwordx2 s[26:27], s[0:1], 72
    v_lshrrev_b32 v1, 6, v0
    v_and_b32 v0, 63, v0
    v_readfirstlane_b32 s32, v1

    s_load_dwordx2 s[44:45], s[0:1], 32
    s_load_dwordx4 s[48:51], s[0:1], 48
    s_load_dwordx2 s[46:47], s[0:1], 64
    s_cmp_ge_u32 s2, 250
    s_cbranch_scc1 L_ge
    s_and_b32 s33, s2, 7
    s_lshr_b32 s34, s2, 3
    s_mul_i32 s35, s34, 52
    s_lshr_b32 s35, s35, 8
    s_mul_i32 s36, s35, 5
    s_sub_u32 s29, s34, s36
    s_mul_i32 s28, s33, 6
    s_add_u32 s28, s28, s35
    s_cmp_lt_u32 s2, 240
    s_cbranch_scc1 L_map_k1
    s_sub_u32 s33, s2, 240
    s_cmp_ge_u32 s33, 5
    s_cselect_b32 s35, 1, 0
    s_add_u32 s28, s35, 48
    s_mul_i32 s35, s35, 5
    s_sub_u32 s29, s33, s35
L_map_k1:
    s_cmp_ge_u32 s28, 25
    s_cselect_b32 s30, 1, 0
    s_mul_i32 s33, s30, 25
    s_sub_u32 s31, s28, s33

    s_mul_i32 s37, s30, 1152000
    s_waitcnt lgkmcnt(0)
    s_add_u32 s8, s4, s37
    s_addc_u32 s9, s5, 0
    s_and_b32 s9, s9, 0xffff
    s_mov_b32 s10, 1152000
    s_mov_b32 s11, 0x20000
    s_mov_b32 s12, s6
    s_and_b32 s13, s7, 0xffff
    s_mov_b32 s14, 622080
    s_mov_b32 s15, 0x20000
    s_mov_b32 s16, s24
    s_and_b32 s17, s25, 0xffff
    s_mov_b32 s18, 622080
    s_mov_b32 s19, 0x20000
    s_mov_b32 s20, s26
    s_and_b32 s21, s27, 0xffff
    s_mov_b32 s22, 16777216
    s_mov_b32 s23, 0x20000
    s_mov_b32 s64, s44
    s_and_b32 s65, s45, 0xffff
    s_mov_b32 s66, 41472
    s_mov_b32 s67, 0x20000
    s_mov_b32 s68, s48
    s_and_b32 s69, s49, 0xffff
    s_mov_b32 s70, 41472
    s_mov_b32 s71, 0x20000
    s_mov_b32 s72, s50
    s_and_b32 s73, s51, 0xffff
    s_mov_b32 s74, 4608000
    s_mov_b32 s75, 0x20000
    s_mov_b32 s76, s46
    s_and_b32 s77, s47, 0xffff
    s_mov_b32 s78, 256
    s_mov_b32 s79, 0x20000
    s_cmp_ge_u32 s32, 4
    s_cbranch_scc1 L_loader
    s_mov_b32 s33, s32
    s_lshl_b32 s34, s33, 6
    v_add_u32 v1, s34, v0
    s_mul_i32 s34, s31, 46080
    s_sub_u32 s34, s34, 6048
    s_mov_b32 s35, -38
    s_mov_b32 s36, -32
    s_movk_i32 s38, 1725
    s_lshl_b32 s39, s33, 10
    s_mov_b32 s40, 0
    v_mov_b32 v9, 2147483648
L_xload:
    v_mul_u32_u24 v2, s38, v1
    v_lshrrev_b32 v2, 16, v2
    v_mad_i32_i24 v3, v2, s35, v1
    v_lshl_add_u32 v4, v1, 4, s34
    v_mad_i32_i24 v4, v2, s36, v4
    v_cmp_lt_u32 vcc, 35, v3
    v_cmp_gt_i32 s[42:43], 0, v4
    s_mov_b32 m0, s39
    v_add_u32 v1, 256, v1
    s_or_b64 vcc, vcc, s[42:43]
    s_add_u32 s39, s39, 4096
    v_cndmask_b32 v4, v4, v9, vcc
    s_add_u32 s40, s40, 1
    buffer_load_dwordx4 v4, s[8:11], 0 offen lds
    s_cmp_lt_u32 s40, 15
    s_cbranch_scc1 L_xload

    s_cmp_lg_u32 s32, 0
    s_cbranch_scc1 L_noreset
    s_mul_i32 s39, s28, 640
    s_add_u32 s39, s39, 3670016
    s_lshl_b32 s40, s29, 7
    s_add_u32 s39, s39, s40
    v_lshl_add_u32 v1, v0, 2, s39
    v_mov_b32 v2, 2147483648
    v_cmp_gt_u32 vcc, 32, v0
    v_mov_b32 v3, 0
    s_nop 0
    v_cndmask_b32 v1, v2, v1, vcc
    buffer_store_dword v3, v1, s[20:23], 0 offen sc1
L_noreset:

    s_and_b32 s33, s32, 1
    s_lshr_b32 s34, s32, 1
    v_and_b32 v1, 15, v0
    v_lshrrev_b32 v2, 4, v0
    v_lshrrev_b32 v3, 2, v1
    v_lshl_add_u32 v3, v2, 3, v3
    v_lshlrev_b32 v3, 6, v3
    v_and_b32 v4, 1, v2
    v_lshl_add_u32 v3, v4, 5, v3
    v_and_b32 v4, 3, v1
    v_lshl_add_u32 v3, v4, 3, v3
    s_lshl_b32 s35, s33, 5
    v_xor_b32 v4, s35, v3
    s_mul_i32 s35, s34, 48
    v_add_u32 v6, s35, v1
    v_mul_u32_u24 v7, 608, v6
    v_lshl_add_u32 v7, v2, 4, v7
    s_mov_b32 s36, 61440
    s_mov_b32 s38, 0

    v_mov_b32 v32, 0
    v_mov_b32 v33, 0
    v_mov_b32 v34, 0
    v_mov_b32 v35, 0
    v_mov_b32 v36, 0
    v_mov_b32 v37, 0
    v_mov_b32 v38, 0
    v_mov_b32 v39, 0
    v_mov_b32 v40, 0
    v_mov_b32 v41, 0
    v_mov_b32 v42, 0
    v_mov_b32 v43, 0
    s_waitcnt vmcnt(0)
    s_cmp_lg_u32 s32, 0
    s_cbranch_scc1 L_nocount
    v_cmp_eq_u32 vcc, 0, v0
    v_mov_b32 v18, s28
    v_lshlrev_b32 v18, 2, v18
    v_mov_b32 v19, 2147483648
    v_cndmask_b32 v18, v19, v18, vcc
    v_mov_b32 v19, 1
    buffer_atomic_add v19, v18, s[76:79], 0 offen sc0 sc1
L_nocount:

    s_barrier
    ds_read_b128 v[80:83], v7 offset:0
    ds_read_b128 v[84:87], v7 offset:9728
    ds_read_b128 v[88:91], v7 offset:19456
    ds_read_b128 v[92:95], v7 offset:64
    ds_read_b128 v[96:99], v7 offset:9792
    ds_read_b128 v[100:103], v7 offset:19520
    ds_read_b128 v[104:107], v7 offset:128
    ds_read_b128 v[108:111], v7 offset:9856
    ds_read_b128 v[112:115], v7 offset:19584
    ds_read_b128 v[116:119], v7 offset:192
    ds_read_b128 v[120:123], v7 offset:9920
    ds_read_b128 v[124:127], v7 offset:19648
    ds_read_b128 v[128:131], v7 offset:256
    ds_read_b128 v[132:135], v7 offset:9984
    ds_read_b128 v[136:139], v7 offset:19712
    ds_read_b128 v[140:143], v7 offset:320
    ds_read_b128 v[144:147], v7 offset:10048
    ds_read_b128 v[148:151], v7 offset:19776
    ds_read_b128 v[152:155], v7 offset:384
    ds_read_b128 v[156:159], v7 offset:10112
    ds_read_b128 v[160:163], v7 offset:19840
    ds_read_b128 v[164:167], v7 offset:448
    ds_read_b128 v[168:171], v7 offset:10176
    ds_read_b128 v[172:175], v7 offset:19904
    ds_read_b128 v[176:179], v7 offset:512
    ds_read_b128 v[180:183], v7 offset:10240
    ds_read_b128 v[184:187], v7 offset:19968
    s_branch L_c1b
L_c1:
    s_barrier
L_c1b:
    v_add_u32 v8, s36, v4
    v_add_u32 v7, 608, v7
    ds_read_b64_tr_b16 v[44:45], v8 offset:0
    ds_read_b64_tr_b16 v[46:47], v8 offset:256
    ds_read_b64_tr_b16 v[48:49], v8 offset:2048
    ds_read_b64_tr_b16 v[50:51], v8 offset:2304
    ds_read_b64_tr_b16 v[52:53], v8 offset:4096
    ds_read_b64_tr_b16 v[54:55], v8 offset:4352
    s_add_u32 s36, s36, 18432
    s_cmp_ge_u32 s36, 153600
    s_cselect_b32 s36, 61440, s36
    s_waitcnt lgkmcnt(4)
    v_mfma_f32_16x16x32_bf16 v[32:35], v[44:47], v[80:83], v[32:35]
    ds_read_b64_tr_b16 v[56:57], v8 offset:6144
    ds_read_b64_tr_b16 v[58:59], v8 offset:6400
    v_mfma_f32_16x16x32_bf16 v[36:39], v[44:47], v[84:87], v[36:39]
    ds_read_b128 v[80:83], v7 offset:0
    v_mfma_f32_16x16x32_bf16 v[40:43], v[44:47], v[88:91], v[40:43]
    ds_read_b128 v[84:87], v7 offset:9728
    ds_read_b128 v[88:91], v7 offset:19456
    s_waitcnt lgkmcnt(7)
    v_mfma_f32_16x16x32_bf16 v[32:35], v[48:51], v[92:95], v[32:35]
    ds_read_b64_tr_b16 v[60:61], v8 offset:8192
    ds_read_b64_tr_b16 v[62:63], v8 offset:8448
    v_mfma_f32_16x16x32_bf16 v[36:39], v[48:51], v[96:99], v[36:39]
    ds_read_b128 v[92:95], v7 offset:64
    v_mfma_f32_16x16x32_bf16 v[40:43], v[48:51], v[100:103], v[40:43]
    ds_read_b128 v[96:99], v7 offset:9792
    ds_read_b128 v[100:103], v7 offset:19520
    s_waitcnt lgkmcnt(10)
    v_mfma_f32_16x16x32_bf16 v[32:35], v[52:55], v[104:107], v[32:35]
    ds_read_b64_tr_b16 v[64:65], v8 offset:10240
    ds_read_b64_tr_b16 v[66:67], v8 offset:10496
    v_mfma_f32_16x16x32_bf16 v[36:39], v[52:55], v[108:111], v[36:39]
    ds_read_b128 v[104:107], v7 offset:128
    v_mfma_f32_16x16x32_bf16 v[40:43], v[52:55], v[112:115], v[40:43]
    ds_read_b128 v[108:111], v7 offset:9856
    ds_read_b128 v[112:115], v7 offset:19584
    s_waitcnt lgkmcnt(13)
    v_mfma_f32_16x16x32_bf16 v[32:35], v[56:59], v[116:119], v[32:35]
    ds_read_b64_tr_b16 v[68:69], v8 offset:12288
    ds_read_b64_tr_b16 v[70:71], v8 offset:12544
    v_mfma_f32_16x16x32_bf16 v[36:39], v[56:59], v[120:123], v[36:39]
    ds_read_b128 v[116:119], v7 offset:192
    v_mfma_f32_16x16x32_bf16 v[40:43], v[56:59], v[124:127], v[40:43]
    ds_read_b128 v[120:123], v7 offset:9920
    ds_read_b128 v[124:127], v7 offset:19648
    s_waitcnt lgkmcnt(13)
    v_mfma_f32_16x16x32_bf16 v[32:35], v[60:63], v[128:131], v[32:35]
    ds_read_b64_tr_b16 v[72:73], v8 offset:14336
    ds_read_b64_tr_b16 v[74:75], v8 offset:14592
    v_mfma_f32_16x16x32_bf16 v[36:39], v[60:63], v[132:135], v[36:39]
    ds_read_b128 v[128:131], v7 offset:256
    v_mfma_f32_16x16x32_bf16 v[40:43], v[60:63], v[136:139], v[40:43]
    ds_read_b128 v[132:135], v7 offset:9984
    ds_read_b128 v[136:139], v7 offset:19712
    s_waitcnt lgkmcnt(13)
    v_mfma_f32_16x16x32_bf16 v[32:35], v[64:67], v[140:143], v[32:35]
    ds_read_b64_tr_b16 v[76:77], v8 offset:16384
    ds_read_b64_tr_b16 v[78:79], v8 offset:16640
    v_mfma_f32_16x16x32_bf16 v[36:39], v[64:67], v[144:147], v[36:39]
    ds_read_b128 v[140:143], v7 offset:320
    v_mfma_f32_16x16x32_bf16 v[40:43], v[64:67], v[148:151], v[40:43]
    ds_read_b128 v[144:147], v7 offset:10048
    ds_read_b128 v[148:151], v7 offset:19776
    s_waitcnt lgkmcnt(13)
    v_mfma_f32_16x16x32_bf16 v[32:35], v[68:71], v[152:155], v[32:35]
    v_mfma_f32_16x16x32_bf16 v[36:39], v[68:71], v[156:159], v[36:39]
    ds_read_b128 v[152:155], v7 offset:384
    v_mfma_f32_16x16x32_bf16 v[40:43], v[68:71], v[160:163], v[40:43]
    ds_read_b128 v[156:159], v7 offset:10112
    ds_read_b128 v[160:163], v7 offset:19840
    s_waitcnt lgkmcnt(11)
    v_mfma_f32_16x16x32_bf16 v[32:35], v[72:75], v[164:167], v[32:35]
    v_mfma_f32_16x16x32_bf16 v[36:39], v[72:75], v[168:171], v[36:39]
    ds_read_b128 v[164:167], v7 offset:448
    v_mfma_f32_16x16x32_bf16 v[40:43], v[72:75], v[172:175], v[40:43]
    ds_read_b128 v[168:171], v7 offset:10176
    ds_read_b128 v[172:175], v7 offset:19904
    s_waitcnt lgkmcnt(9)
    v_mfma_f32_16x16x32_bf16 v[32:35], v[76:79], v[176:179], v[32:35]
    v_mfma_f32_16x16x32_bf16 v[36:39], v[76:79], v[180:183], v[36:39]
    ds_read_b128 v[176:179], v7 offset:512
    v_mfma_f32_16x16x32_bf16 v[40:43], v[76:79], v[184:187], v[40:43]
    ds_read_b128 v[180:183], v7 offset:10240
    ds_read_b128 v[184:187], v7 offset:19968
    s_add_u32 s38, s38, 1
    s_cmp_lt_u32 s38, 7
    s_cbranch_scc1 L_c1
    s_barrier
    v_add_u32 v8, s36, v4
    ds_read_b64_tr_b16 v[44:45], v8 offset:0
    ds_read_b64_tr_b16 v[46:47], v8 offset:256
    ds_read_b64_tr_b16 v[48:49], v8 offset:2048
    ds_read_b64_tr_b16 v[50:51], v8 offset:2304
    ds_read_b64_tr_b16 v[52:53], v8 offset:4096
    ds_read_b64_tr_b16 v[54:55], v8 offset:4352
    s_add_u32 s36, s36, 18432
    s_cmp_ge_u32 s36, 153600
    s_cselect_b32 s36, 61440, s36
    s_waitcnt lgkmcnt(4)
    v_mfma_f32_16x16x32_bf16 v[32:35], v[44:47], v[80:83], v[32:35]
    ds_read_b64_tr_b16 v[56:57], v8 offset:6144
    ds_read_b64_tr_b16 v[58:59], v8 offset:6400
    v_mfma_f32_16x16x32_bf16 v[36:39], v[44:47], v[84:87], v[36:39]
    v_mfma_f32_16x16x32_bf16 v[40:43], v[44:47], v[88:91], v[40:43]
    s_waitcnt lgkmcnt(4)
    v_mfma_f32_16x16x32_bf16 v[32:35], v[48:51], v[92:95], v[32:35]
    ds_read_b64_tr_b16 v[60:61], v8 offset:8192
    ds_read_b64_tr_b16 v[62:63], v8 offset:8448
    v_mfma_f32_16x16x32_bf16 v[36:39], v[48:51], v[96:99], v[36:39]
    v_mfma_f32_16x16x32_bf16 v[40:43], v[48:51], v[100:103], v[40:43]
    s_waitcnt lgkmcnt(4)
    v_mfma_f32_16x16x32_bf16 v[32:35], v[52:55], v[104:107], v[32:35]
    v_mfma_f32_16x16x32_bf16 v[36:39], v[52:55], v[108:111], v[36:39]
    v_mfma_f32_16x16x32_bf16 v[40:43], v[52:55], v[112:115], v[40:43]
    s_waitcnt lgkmcnt(2)
    v_mfma_f32_16x16x32_bf16 v[32:35], v[56:59], v[116:119], v[32:35]
    v_mfma_f32_16x16x32_bf16 v[36:39], v[56:59], v[120:123], v[36:39]
    v_mfma_f32_16x16x32_bf16 v[40:43], v[56:59], v[124:127], v[40:43]
    s_waitcnt lgkmcnt(0)
    v_mfma_f32_16x16x32_bf16 v[32:35], v[60:63], v[128:131], v[32:35]
    v_mfma_f32_16x16x32_bf16 v[36:39], v[60:63], v[132:135], v[36:39]
    v_mfma_f32_16x16x32_bf16 v[40:43], v[60:63], v[136:139], v[40:43]
    s_waitcnt lgkmcnt(0)
    s_barrier
    s_cmp_lg_u32 s32, 0
    s_cbranch_scc1 L_nobc
    s_waitcnt vmcnt(0)
    v_readfirstlane_b32 s39, v19
    s_mul_i32 s40, s39, 52429
    s_lshr_b32 s40, s40, 18
    s_mul_i32 s40, s40, 5
    s_sub_u32 s39, s39, s40
    s_cmp_lg_u32 s39, 4
    s_cbranch_scc1 L_nobc
    s_mul_i32 s39, s28, 640
    s_add_u32 s39, s39, 3670016
    s_add_u32 s39, s39, 84
    v_lshl_add_u32 v18, v0, 7, s39
    v_mov_b32 v19, 2147483648
    v_cmp_gt_u32 vcc, 5, v0
    v_mov_b32 v20, 1
    s_nop 0
    v_cndmask_b32 v18, v19, v18, vcc
    buffer_store_dword v20, v18, s[20:23], 0 offen sc1
L_nobc:

    v_mul_u32_u24 v14, 80, v6
    v_lshl_add_u32 v14, v2, 3, v14
    s_lshl_b32 s39, s33, 5
    s_add_u32 s39, s39, 153600
    v_add_u32 v14, s39, v14
    s_mul_i32 s39, s31, 80
    s_sub_u32 s39, s39, 7
    v_add_u32 v15, s39, v6
    s_mov_b32 s40, 3222493025
    s_mov_b32 s41, 3222493025
    v_mov_b32 v16, 3184710632
    v_mov_b32 v17, 3184710632
    s_movk_i32 s42, 2000

    v_lshrrev_b32 v10, 5, v0
    v_lshlrev_b32 v10, 4, v10
    v_bfe_u32 v11, v0, 4, 1
    v_lshl_add_u32 v10, v11, 2, v10
    v_bfe_u32 v11, v0, 2, 2
    v_add_u32 v10, v10, v11
    v_mul_u32_u24 v10, 288, v10
    v_and_b32 v11, 3, v0
    v_lshl_add_u32 v4, v11, 3, v10

    v_pk_mul_f32 v[64:65], v[32:33], v[32:33]
    v_pk_mul_f32 v[66:67], v[34:35], v[34:35]
    v_pk_mul_f32 v[68:69], v[36:37], v[36:37]
    v_pk_mul_f32 v[70:71], v[38:39], v[38:39]
    v_pk_mul_f32 v[72:73], v[40:41], v[40:41]
    v_pk_mul_f32 v[74:75], v[42:43], v[42:43]
    v_pk_fma_f32 v[64:65], v[64:65], v[16:17], s[40:41]
    v_pk_fma_f32 v[66:67], v[66:67], v[16:17], s[40:41]
    v_pk_fma_f32 v[68:69], v[68:69], v[16:17], s[40:41]
    v_pk_fma_f32 v[70:71], v[70:71], v[16:17], s[40:41]
    v_pk_fma_f32 v[72:73], v[72:73], v[16:17], s[40:41]
    v_pk_fma_f32 v[74:75], v[74:75], v[16:17], s[40:41]
    v_pk_mul_f32 v[64:65], v[64:65], v[32:33]
    v_pk_mul_f32 v[66:67], v[66:67], v[34:35]
    v_pk_mul_f32 v[68:69], v[68:69], v[36:37]
    v_pk_mul_f32 v[70:71], v[70:71], v[38:39]
    v_pk_mul_f32 v[72:73], v[72:73], v[40:41]
    v_pk_mul_f32 v[74:75], v[74:75], v[42:43]
    v_exp_f32 v64, v64
    v_exp_f32 v65, v65
    v_exp_f32 v66, v66
    v_exp_f32 v67, v67
    v_exp_f32 v68, v68
    v_exp_f32 v69, v69
    v_exp_f32 v70, v70
    v_exp_f32 v71, v71
    v_exp_f32 v72, v72
    v_exp_f32 v73, v73
    v_exp_f32 v74, v74
    v_exp_f32 v75, v75
    v_pk_add_f32 v[64:65], v[64:65], 1.0 op_sel_hi:[1,0]
    v_pk_add_f32 v[66:67], v[66:67], 1.0 op_sel_hi:[1,0]
    v_pk_add_f32 v[68:69], v[68:69], 1.0 op_sel_hi:[1,0]
    v_pk_add_f32 v[70:71], v[70:71], 1.0 op_sel_hi:[1,0]
    v_pk_add_f32 v[72:73], v[72:73], 1.0 op_sel_hi:[1,0]
    v_pk_add_f32 v[74:75], v[74:75], 1.0 op_sel_hi:[1,0]
    v_rcp_f32 v64, v64
    v_rcp_f32 v65, v65
    v_rcp_f32 v66, v66
    v_rcp_f32 v67, v67
    v_rcp_f32 v68, v68
    v_rcp_f32 v69, v69
    v_rcp_f32 v70, v70
    v_rcp_f32 v71, v71
    v_rcp_f32 v72, v72
    v_rcp_f32 v73, v73
    v_rcp_f32 v74, v74
    v_rcp_f32 v75, v75
    v_pk_mul_f32 v[32:33], v[32:33], v[64:65]
    v_pk_mul_f32 v[34:35], v[34:35], v[66:67]
    v_pk_mul_f32 v[36:37], v[36:37], v[68:69]
    v_pk_mul_f32 v[38:39], v[38:39], v[70:71]
    v_pk_mul_f32 v[40:41], v[40:41], v[72:73]
    v_pk_mul_f32 v[42:43], v[42:43], v[74:75]
    v_add_u32 v18, 0, v15
    v_cmp_gt_u32 vcc, s42, v18
    v_cvt_pk_bf16_f32 v64, v32, v33
    v_cvt_pk_bf16_f32 v65, v34, v35
    v_cndmask_b32 v66, 0, v64, vcc
    v_cndmask_b32 v67, 0, v65, vcc
    ds_write_b64 v14, v[66:67] offset:0
    v_add_u32 v18, 16, v15
    v_cmp_gt_u32 vcc, s42, v18
    v_cvt_pk_bf16_f32 v64, v36, v37
    v_cvt_pk_bf16_f32 v65, v38, v39
    v_cndmask_b32 v68, 0, v64, vcc
    v_cndmask_b32 v69, 0, v65, vcc
    ds_write_b64 v14, v[68:69] offset:1280
    v_add_u32 v18, 32, v15
    v_cmp_gt_u32 vcc, s42, v18
    v_cvt_pk_bf16_f32 v64, v40, v41
    v_cvt_pk_bf16_f32 v65, v42, v43
    v_cndmask_b32 v70, 0, v64, vcc
    v_cndmask_b32 v71, 0, v65, vcc
    ds_write_b64 v14, v[70:71] offset:2560
    s_lshl_b32 s39, s32, 6
    v_add_u32 v5, 256, v4
    v_add_u32 v4, s39, v4
    v_mul_u32_u24 v6, 160, v1
    v_lshl_add_u32 v6, v2, 4, v6
    v_add_u32 v6, 153600, v6
    s_min_u32 s39, s32, 2
    s_mul_i32 s39, s39, 2560
    v_add_u32 v7, s39, v6
    s_mov_b32 s38, 0

    s_waitcnt lgkmcnt(0)
    v_add_u32 v8, 61440, v4
    v_add_u32 v9, 61440, v5
    v_add_u32 v12, 116736, v4
    v_add_u32 v13, 116736, v5

    s_barrier
    ds_read_b64_tr_b16 v[64:65], v12 offset:0
    ds_read_b64_tr_b16 v[66:67], v12 offset:2304
    ds_read_b64_tr_b16 v[68:69], v12 offset:32
    ds_read_b64_tr_b16 v[70:71], v12 offset:2336
    ds_read_b64_tr_b16 v[72:73], v13 offset:0
    ds_read_b64_tr_b16 v[74:75], v13 offset:2304
    ds_read_b128 v[92:95], v6 offset:0
    ds_read_b128 v[96:99], v6 offset:2560
    ds_read_b128 v[100:103], v6 offset:5120
    ds_read_b128 v[104:107], v7 offset:0
    ds_read_b64_tr_b16 v[76:77], v12 offset:9216
    ds_read_b64_tr_b16 v[78:79], v12 offset:11520
    ds_read_b64_tr_b16 v[80:81], v12 offset:9248
    ds_read_b64_tr_b16 v[82:83], v12 offset:11552
    ds_read_b64_tr_b16 v[84:85], v13 offset:9216
    ds_read_b64_tr_b16 v[86:87], v13 offset:11520
    ds_read_b128 v[108:111], v6 offset:80
    ds_read_b128 v[112:115], v6 offset:2640
    ds_read_b128 v[116:119], v6 offset:5200
    ds_read_b128 v[120:123], v7 offset:80
    s_waitcnt lgkmcnt(10)
    v_mfma_f32_16x16x32_bf16 v[32:35], v[64:67], v[92:95], 0
    v_mfma_f32_16x16x32_bf16 v[36:39], v[64:67], v[96:99], 0
    v_mfma_f32_16x16x32_bf16 v[40:43], v[64:67], v[100:103], 0
    ds_read_b64_tr_b16 v[64:65], v12 offset:18432
    ds_read_b64_tr_b16 v[66:67], v12 offset:20736
    v_mfma_f32_16x16x32_bf16 v[44:47], v[68:71], v[92:95], 0
    ds_read_b128 v[92:95], v6 offset:160
    v_mfma_f32_16x16x32_bf16 v[48:51], v[68:71], v[96:99], 0
    ds_read_b128 v[96:99], v6 offset:2720
    v_mfma_f32_16x16x32_bf16 v[52:55], v[68:71], v[100:103], 0
    ds_read_b128 v[100:103], v6 offset:5280
    ds_read_b64_tr_b16 v[68:69], v12 offset:18464
    ds_read_b64_tr_b16 v[70:71], v12 offset:20768
    v_mfma_f32_16x16x32_bf16 v[56:59], v[72:75], v[104:107], 0
    ds_read_b64_tr_b16 v[72:73], v13 offset:18432
    ds_read_b64_tr_b16 v[74:75], v13 offset:20736
    ds_read_b128 v[104:107], v7 offset:160
    s_waitcnt lgkmcnt(10)
    v_mfma_f32_16x16x32_bf16 v[32:35], v[76:79], v[108:111], v[32:35]
    v_mfma_f32_16x16x32_bf16 v[36:39], v[76:79], v[112:115], v[36:39]
    v_mfma_f32_16x16x32_bf16 v[40:43], v[76:79], v[116:119], v[40:43]
    ds_read_b64_tr_b16 v[76:77], v12 offset:27648
    ds_read_b64_tr_b16 v[78:79], v12 offset:29952
    v_mfma_f32_16x16x32_bf16 v[44:47], v[80:83], v[108:111], v[44:47]
    ds_read_b128 v[108:111], v6 offset:240
    v_mfma_f32_16x16x32_bf16 v[48:51], v[80:83], v[112:115], v[48:51]
    ds_read_b128 v[112:115], v6 offset:2800
    v_mfma_f32_16x16x32_bf16 v[52:55], v[80:83], v[116:119], v[52:55]
    ds_read_b128 v[116:119], v6 offset:5360
    ds_read_b64_tr_b16 v[80:81], v12 offset:27680
    ds_read_b64_tr_b16 v[82:83], v12 offset:29984
    v_mfma_f32_16x16x32_bf16 v[56:59], v[84:87], v[120:123], v[56:59]
    ds_read_b64_tr_b16 v[84:85], v13 offset:27648
    ds_read_b64_tr_b16 v[86:87], v13 offset:29952
    ds_read_b128 v[120:123], v7 offset:240
    s_waitcnt lgkmcnt(10)
    v_mfma_f32_16x16x32_bf16 v[32:35], v[64:67], v[92:95], v[32:35]
    v_mfma_f32_16x16x32_bf16 v[36:39], v[64:67], v[96:99], v[36:39]
    v_mfma_f32_16x16x32_bf16 v[40:43], v[64:67], v[100:103], v[40:43]
    ds_read_b64_tr_b16 v[64:65], v8 offset:0
    ds_read_b64_tr_b16 v[66:67], v8 offset:2304
    v_mfma_f32_16x16x32_bf16 v[44:47], v[68:71], v[92:95], v[44:47]
    ds_read_b128 v[92:95], v6 offset:320
    v_mfma_f32_16x16x32_bf16 v[48:51], v[68:71], v[96:99], v[48:51]
    ds_read_b128 v[96:99], v6 offset:2880
    v_mfma_f32_16x16x32_bf16 v[52:55], v[68:71], v[100:103], v[52:55]
    ds_read_b128 v[100:103], v6 offset:5440
    ds_read_b64_tr_b16 v[68:69], v8 offset:32
    ds_read_b64_tr_b16 v[70:71], v8 offset:2336
    v_mfma_f32_16x16x32_bf16 v[56:59], v[72:75], v[104:107], v[56:59]
    ds_read_b64_tr_b16 v[72:73], v9 offset:0
    ds_read_b64_tr_b16 v[74:75], v9 offset:2304
    ds_read_b128 v[104:107], v7 offset:320
    s_waitcnt lgkmcnt(10)
    v_mfma_f32_16x16x32_bf16 v[32:35], v[76:79], v[108:111], v[32:35]
    v_mfma_f32_16x16x32_bf16 v[36:39], v[76:79], v[112:115], v[36:39]
    v_mfma_f32_16x16x32_bf16 v[40:43], v[76:79], v[116:119], v[40:43]
    ds_read_b64_tr_b16 v[76:77], v8 offset:9216
    ds_read_b64_tr_b16 v[78:79], v8 offset:11520
    v_mfma_f32_16x16x32_bf16 v[44:47], v[80:83], v[108:111], v[44:47]
    ds_read_b128 v[108:111], v6 offset:400
    v_mfma_f32_16x16x32_bf16 v[48:51], v[80:83], v[112:115], v[48:51]
    ds_read_b128 v[112:115], v6 offset:2960
    v_mfma_f32_16x16x32_bf16 v[52:55], v[80:83], v[116:119], v[52:55]
    ds_read_b128 v[116:119], v6 offset:5520
    ds_read_b64_tr_b16 v[80:81], v8 offset:9248
    ds_read_b64_tr_b16 v[82:83], v8 offset:11552
    v_mfma_f32_16x16x32_bf16 v[56:59], v[84:87], v[120:123], v[56:59]
    ds_read_b64_tr_b16 v[84:85], v9 offset:9216
    ds_read_b64_tr_b16 v[86:87], v9 offset:11520
    ds_read_b128 v[120:123], v7 offset:400
    s_waitcnt lgkmcnt(10)
    v_mfma_f32_16x16x32_bf16 v[32:35], v[64:67], v[92:95], v[32:35]
    v_mfma_f32_16x16x32_bf16 v[36:39], v[64:67], v[96:99], v[36:39]
    v_mfma_f32_16x16x32_bf16 v[40:43], v[64:67], v[100:103], v[40:43]
    ds_read_b64_tr_b16 v[64:65], v8 offset:18432
    ds_read_b64_tr_b16 v[66:67], v8 offset:20736
    v_mfma_f32_16x16x32_bf16 v[44:47], v[68:71], v[92:95], v[44:47]
    ds_read_b128 v[92:95], v6 offset:480
    v_mfma_f32_16x16x32_bf16 v[48:51], v[68:71], v[96:99], v[48:51]
    ds_read_b128 v[96:99], v6 offset:3040
    v_mfma_f32_16x16x32_bf16 v[52:55], v[68:71], v[100:103], v[52:55]
    ds_read_b128 v[100:103], v6 offset:5600
    ds_read_b64_tr_b16 v[68:69], v8 offset:18464
    ds_read_b64_tr_b16 v[70:71], v8 offset:20768
    v_mfma_f32_16x16x32_bf16 v[56:59], v[72:75], v[104:107], v[56:59]
    ds_read_b64_tr_b16 v[72:73], v9 offset:18432
    ds_read_b64_tr_b16 v[74:75], v9 offset:20736
    ds_read_b128 v[104:107], v7 offset:480
    s_waitcnt lgkmcnt(10)
    v_mfma_f32_16x16x32_bf16 v[32:35], v[76:79], v[108:111], v[32:35]
    v_mfma_f32_16x16x32_bf16 v[36:39], v[76:79], v[112:115], v[36:39]
    v_mfma_f32_16x16x32_bf16 v[40:43], v[76:79], v[116:119], v[40:43]
    ds_read_b64_tr_b16 v[76:77], v8 offset:27648
    ds_read_b64_tr_b16 v[78:79], v8 offset:29952
    v_mfma_f32_16x16x32_bf16 v[44:47], v[80:83], v[108:111], v[44:47]
    ds_read_b128 v[108:111], v6 offset:560
    v_mfma_f32_16x16x32_bf16 v[48:51], v[80:83], v[112:115], v[48:51]
    ds_read_b128 v[112:115], v6 offset:3120
    v_mfma_f32_16x16x32_bf16 v[52:55], v[80:83], v[116:119], v[52:55]
    ds_read_b128 v[116:119], v6 offset:5680
    ds_read_b64_tr_b16 v[80:81], v8 offset:27680
    ds_read_b64_tr_b16 v[82:83], v8 offset:29984
    v_mfma_f32_16x16x32_bf16 v[56:59], v[84:87], v[120:123], v[56:59]
    ds_read_b64_tr_b16 v[84:85], v9 offset:27648
    ds_read_b64_tr_b16 v[86:87], v9 offset:29952
    ds_read_b128 v[120:123], v7 offset:560
    s_barrier
    s_waitcnt lgkmcnt(10)
    v_mfma_f32_16x16x32_bf16 v[32:35], v[64:67], v[92:95], v[32:35]
    v_mfma_f32_16x16x32_bf16 v[36:39], v[64:67], v[96:99], v[36:39]
    v_mfma_f32_16x16x32_bf16 v[40:43], v[64:67], v[100:103], v[40:43]
    ds_read_b64_tr_b16 v[64:65], v4 offset:0
    ds_read_b64_tr_b16 v[66:67], v4 offset:2304
    v_mfma_f32_16x16x32_bf16 v[44:47], v[68:71], v[92:95], v[44:47]
    ds_read_b128 v[92:95], v6 offset:640
    v_mfma_f32_16x16x32_bf16 v[48:51], v[68:71], v[96:99], v[48:51]
    ds_read_b128 v[96:99], v6 offset:3200
    v_mfma_f32_16x16x32_bf16 v[52:55], v[68:71], v[100:103], v[52:55]
    ds_read_b128 v[100:103], v6 offset:5760
    ds_read_b64_tr_b16 v[68:69], v4 offset:32
    ds_read_b64_tr_b16 v[70:71], v4 offset:2336
    v_mfma_f32_16x16x32_bf16 v[56:59], v[72:75], v[104:107], v[56:59]
    ds_read_b64_tr_b16 v[72:73], v5 offset:0
    ds_read_b64_tr_b16 v[74:75], v5 offset:2304
    ds_read_b128 v[104:107], v7 offset:640
    s_waitcnt lgkmcnt(10)
    v_mfma_f32_16x16x32_bf16 v[32:35], v[76:79], v[108:111], v[32:35]
    v_mfma_f32_16x16x32_bf16 v[36:39], v[76:79], v[112:115], v[36:39]
    v_mfma_f32_16x16x32_bf16 v[40:43], v[76:79], v[116:119], v[40:43]
    ds_read_b64_tr_b16 v[76:77], v4 offset:9216
    ds_read_b64_tr_b16 v[78:79], v4 offset:11520
    v_mfma_f32_16x16x32_bf16 v[44:47], v[80:83], v[108:111], v[44:47]
    ds_read_b128 v[108:111], v6 offset:720
    v_mfma_f32_16x16x32_bf16 v[48:51], v[80:83], v[112:115], v[48:51]
    ds_read_b128 v[112:115], v6 offset:3280
    v_mfma_f32_16x16x32_bf16 v[52:55], v[80:83], v[116:119], v[52:55]
    ds_read_b128 v[116:119], v6 offset:5840
    ds_read_b64_tr_b16 v[80:81], v4 offset:9248
    ds_read_b64_tr_b16 v[82:83], v4 offset:11552
    v_mfma_f32_16x16x32_bf16 v[56:59], v[84:87], v[120:123], v[56:59]
    ds_read_b64_tr_b16 v[84:85], v5 offset:9216
    ds_read_b64_tr_b16 v[86:87], v5 offset:11520
    ds_read_b128 v[120:123], v7 offset:720
    s_barrier
    s_waitcnt lgkmcnt(10)
    v_mfma_f32_16x16x32_bf16 v[32:35], v[64:67], v[92:95], v[32:35]
    v_mfma_f32_16x16x32_bf16 v[36:39], v[64:67], v[96:99], v[36:39]
    v_mfma_f32_16x16x32_bf16 v[40:43], v[64:67], v[100:103], v[40:43]
    ds_read_b64_tr_b16 v[64:65], v4 offset:18432
    ds_read_b64_tr_b16 v[66:67], v4 offset:20736
    v_mfma_f32_16x16x32_bf16 v[44:47], v[68:71], v[92:95], v[44:47]
    ds_read_b128 v[92:95], v6 offset:800
    v_mfma_f32_16x16x32_bf16 v[48:51], v[68:71], v[96:99], v[48:51]
    ds_read_b128 v[96:99], v6 offset:3360
    v_mfma_f32_16x16x32_bf16 v[52:55], v[68:71], v[100:103], v[52:55]
    ds_read_b128 v[100:103], v6 offset:5920
    ds_read_b64_tr_b16 v[68:69], v4 offset:18464
    ds_read_b64_tr_b16 v[70:71], v4 offset:20768
    v_mfma_f32_16x16x32_bf16 v[56:59], v[72:75], v[104:107], v[56:59]
    ds_read_b64_tr_b16 v[72:73], v5 offset:18432
    ds_read_b64_tr_b16 v[74:75], v5 offset:20736
    ds_read_b128 v[104:107], v7 offset:800
    s_waitcnt lgkmcnt(10)
    v_mfma_f32_16x16x32_bf16 v[32:35], v[76:79], v[108:111], v[32:35]
    v_mfma_f32_16x16x32_bf16 v[36:39], v[76:79], v[112:115], v[36:39]
    v_mfma_f32_16x16x32_bf16 v[40:43], v[76:79], v[116:119], v[40:43]
    ds_read_b64_tr_b16 v[76:77], v4 offset:27648
    ds_read_b64_tr_b16 v[78:79], v4 offset:29952
    v_mfma_f32_16x16x32_bf16 v[44:47], v[80:83], v[108:111], v[44:47]
    ds_read_b128 v[108:111], v6 offset:880
    v_mfma_f32_16x16x32_bf16 v[48:51], v[80:83], v[112:115], v[48:51]
    ds_read_b128 v[112:115], v6 offset:3440
    v_mfma_f32_16x16x32_bf16 v[52:55], v[80:83], v[116:119], v[52:55]
    ds_read_b128 v[116:119], v6 offset:6000
    ds_read_b64_tr_b16 v[80:81], v4 offset:27680
    ds_read_b64_tr_b16 v[82:83], v4 offset:29984
    v_mfma_f32_16x16x32_bf16 v[56:59], v[84:87], v[120:123], v[56:59]
    ds_read_b64_tr_b16 v[84:85], v5 offset:27648
    ds_read_b64_tr_b16 v[86:87], v5 offset:29952
    ds_read_b128 v[120:123], v7 offset:880
    s_waitcnt lgkmcnt(10)
    v_mfma_f32_16x16x32_bf16 v[32:35], v[64:67], v[92:95], v[32:35]
    v_mfma_f32_16x16x32_bf16 v[36:39], v[64:67], v[96:99], v[36:39]
    v_mfma_f32_16x16x32_bf16 v[40:43], v[64:67], v[100:103], v[40:43]
    ds_read_b64_tr_b16 v[64:65], v4 offset:36864
    ds_read_b64_tr_b16 v[66:67], v4 offset:39168
    v_mfma_f32_16x16x32_bf16 v[44:47], v[68:71], v[92:95], v[44:47]
    ds_read_b128 v[92:95], v6 offset:960
    v_mfma_f32_16x16x32_bf16 v[48:51], v[68:71], v[96:99], v[48:51]
    ds_read_b128 v[96:99], v6 offset:3520
    v_mfma_f32_16x16x32_bf16 v[52:55], v[68:71], v[100:103], v[52:55]
    ds_read_b128 v[100:103], v6 offset:6080
    ds_read_b64_tr_b16 v[68:69], v4 offset:36896
    ds_read_b64_tr_b16 v[70:71], v4 offset:39200
    v_mfma_f32_16x16x32_bf16 v[56:59], v[72:75], v[104:107], v[56:59]
    ds_read_b64_tr_b16 v[72:73], v5 offset:36864
    ds_read_b64_tr_b16 v[74:75], v5 offset:39168
    ds_read_b128 v[104:107], v7 offset:960
    s_waitcnt lgkmcnt(10)
    v_mfma_f32_16x16x32_bf16 v[32:35], v[76:79], v[108:111], v[32:35]
    v_mfma_f32_16x16x32_bf16 v[36:39], v[76:79], v[112:115], v[36:39]
    v_mfma_f32_16x16x32_bf16 v[40:43], v[76:79], v[116:119], v[40:43]
    ds_read_b64_tr_b16 v[76:77], v4 offset:46080
    ds_read_b64_tr_b16 v[78:79], v4 offset:48384
    v_mfma_f32_16x16x32_bf16 v[44:47], v[80:83], v[108:111], v[44:47]
    ds_read_b128 v[108:111], v6 offset:1040
    v_mfma_f32_16x16x32_bf16 v[48:51], v[80:83], v[112:115], v[48:51]
    ds_read_b128 v[112:115], v6 offset:3600
    v_mfma_f32_16x16x32_bf16 v[52:55], v[80:83], v[116:119], v[52:55]
    ds_read_b128 v[116:119], v6 offset:6160
    ds_read_b64_tr_b16 v[80:81], v4 offset:46112
    ds_read_b64_tr_b16 v[82:83], v4 offset:48416
    v_mfma_f32_16x16x32_bf16 v[56:59], v[84:87], v[120:123], v[56:59]
    ds_read_b64_tr_b16 v[84:85], v5 offset:46080
    ds_read_b64_tr_b16 v[86:87], v5 offset:48384
    ds_read_b128 v[120:123], v7 offset:1040
    s_waitcnt lgkmcnt(10)
    v_mfma_f32_16x16x32_bf16 v[32:35], v[64:67], v[92:95], v[32:35]
    v_mfma_f32_16x16x32_bf16 v[36:39], v[64:67], v[96:99], v[36:39]
    v_mfma_f32_16x16x32_bf16 v[40:43], v[64:67], v[100:103], v[40:43]
    ds_read_b64_tr_b16 v[64:65], v8 offset:36864
    ds_read_b64_tr_b16 v[66:67], v8 offset:39168
    v_mfma_f32_16x16x32_bf16 v[44:47], v[68:71], v[92:95], v[44:47]
    ds_read_b128 v[92:95], v6 offset:1120
    v_mfma_f32_16x16x32_bf16 v[48:51], v[68:71], v[96:99], v[48:51]
    ds_read_b128 v[96:99], v6 offset:3680
    v_mfma_f32_16x16x32_bf16 v[52:55], v[68:71], v[100:103], v[52:55]
    ds_read_b128 v[100:103], v6 offset:6240
    ds_read_b64_tr_b16 v[68:69], v8 offset:36896
    ds_read_b64_tr_b16 v[70:71], v8 offset:39200
    v_mfma_f32_16x16x32_bf16 v[56:59], v[72:75], v[104:107], v[56:59]
    ds_read_b64_tr_b16 v[72:73], v9 offset:36864
    ds_read_b64_tr_b16 v[74:75], v9 offset:39168
    ds_read_b128 v[104:107], v7 offset:1120
    s_mul_i32 s39, s28, 640
    s_add_u32 s39, s39, 3670016
    s_lshl_b32 s40, s29, 7
    s_add_u32 s39, s39, s40
    s_add_u32 s39, s39, 84
    v_mov_b32 v20, s39
    buffer_load_dword v21, v20, s[20:23], 0 offen sc1
    s_waitcnt lgkmcnt(10)
    v_mfma_f32_16x16x32_bf16 v[32:35], v[76:79], v[108:111], v[32:35]
    v_mfma_f32_16x16x32_bf16 v[36:39], v[76:79], v[112:115], v[36:39]
    v_mfma_f32_16x16x32_bf16 v[40:43], v[76:79], v[116:119], v[40:43]
    v_mfma_f32_16x16x32_bf16 v[44:47], v[80:83], v[108:111], v[44:47]
    v_mfma_f32_16x16x32_bf16 v[48:51], v[80:83], v[112:115], v[48:51]
    v_mfma_f32_16x16x32_bf16 v[52:55], v[80:83], v[116:119], v[52:55]
    v_mfma_f32_16x16x32_bf16 v[56:59], v[84:87], v[120:123], v[56:59]
    s_waitcnt lgkmcnt(0)
    v_mfma_f32_16x16x32_bf16 v[32:35], v[64:67], v[92:95], v[32:35]
    v_mfma_f32_16x16x32_bf16 v[36:39], v[64:67], v[96:99], v[36:39]
    v_mfma_f32_16x16x32_bf16 v[40:43], v[64:67], v[100:103], v[40:43]
    v_mfma_f32_16x16x32_bf16 v[44:47], v[68:71], v[92:95], v[44:47]
    v_mfma_f32_16x16x32_bf16 v[48:51], v[68:71], v[96:99], v[48:51]
    v_mfma_f32_16x16x32_bf16 v[52:55], v[68:71], v[100:103], v[52:55]
    v_mfma_f32_16x16x32_bf16 v[56:59], v[72:75], v[104:107], v[56:59]
    v_lshrrev_b32 v3, 3, v1
    v_mul_u32_u24 v3, 11520, v3
    v_lshl_add_u32 v3, v2, 6, v3
    v_and_b32 v4, 7, v1
    v_lshl_add_u32 v3, v4, 3, v3
    s_mul_i32 s39, s28, 57600
    s_mul_i32 s40, s29, 2304
    s_add_u32 s39, s39, s40
    s_add_u32 s39, s39, 0
    v_add_u32 v3, s39, v3
    s_lshl_b32 s40, s32, 9
    v_add_u32 v4, s40, v3
    v_mov_b32 v9, 2147483648
    v_cmp_gt_u32 vcc, 8, v1
    s_min_u32 s41, s32, 2
    s_mul_i32 s41, s41, 23040
    v_cndmask_b32 v5, v9, v4, vcc
    s_add_u32 s41, s41, 2048
    v_add_u32 v6, s41, v3
    v_cndmask_b32 v7, v9, v6, vcc
    s_cmp_eq_u32 s32, 2
    s_cselect_b64 vcc, -1, 0
    v_cndmask_b32 v6, v6, v7, vcc
    s_cmp_eq_u32 s32, 3
    s_cselect_b64 vcc, -1, 0
    v_cndmask_b32 v6, v6, v9, vcc
    s_movk_i32 s42, 23040
    s_mov_b32 s43, 46080

    v_cvt_pk_bf16_f32 v64, v32, v33
    v_cvt_pk_bf16_f32 v65, v34, v35
    v_cvt_pk_bf16_f32 v66, v36, v37
    v_cvt_pk_bf16_f32 v67, v38, v39
    v_cvt_pk_bf16_f32 v68, v40, v41
    v_cvt_pk_bf16_f32 v69, v42, v43
    v_cvt_pk_bf16_f32 v70, v44, v45
    v_cvt_pk_bf16_f32 v71, v46, v47
    v_cvt_pk_bf16_f32 v72, v48, v49
    v_cvt_pk_bf16_f32 v73, v50, v51
    v_cvt_pk_bf16_f32 v74, v52, v53
    v_cvt_pk_bf16_f32 v75, v54, v55
    v_cvt_pk_bf16_f32 v76, v56, v57
    v_cvt_pk_bf16_f32 v77, v58, v59
    buffer_store_dwordx2 v[64:65], v4, s[20:23], 0 offen offset:0 sc1
    buffer_store_dwordx2 v[66:67], v4, s[20:23], s42 offen offset:0 sc1
    buffer_store_dwordx2 v[68:69], v5, s[20:23], s43 offen offset:0 sc1
    buffer_store_dwordx2 v[70:71], v4, s[20:23], 0 offen offset:256 sc1
    buffer_store_dwordx2 v[72:73], v4, s[20:23], s42 offen offset:256 sc1
    buffer_store_dwordx2 v[74:75], v5, s[20:23], s43 offen offset:256 sc1
    buffer_store_dwordx2 v[76:77], v6, s[20:23], 0 offen sc1
    s_mul_i32 s39, s28, 640
    s_add_u32 s39, s39, 3670016
    s_lshl_b32 s40, s29, 4
    s_add_u32 s39, s39, s40
    s_lshl_b32 s40, s32, 2
    s_add_u32 s39, s39, s40
    v_lshl_add_u32 v1, v0, 7, s39
    v_mov_b32 v2, 2147483648
    v_cmp_gt_u32 vcc, 5, v0
    v_mov_b32 v3, 1
    s_nop 0
    v_cndmask_b32 v1, v2, v1, vcc

    s_mov_b32 s40, 0
L_rdy:
    s_waitcnt vmcnt(0)
    v_cmp_ne_u32 vcc, 1, v21
    s_add_u32 s40, s40, 1
    s_nop 0
    s_cmp_eq_u64 vcc, 0
    s_cbranch_scc1 L_rdy_done
    s_cmp_ge_u32 s40, 400000
    s_cbranch_scc1 L_rdy_done
    buffer_load_dword v21, v20, s[20:23], 0 offen sc1
    s_branch L_rdy
L_rdy_done:

    buffer_store_dword v3, v1, s[20:23], 0 offen sc1
    s_branch L_k2
L_loader:
    s_sub_u32 s33, s32, 4
    v_mov_b32 v9, 2147483648
    v_lshrrev_b32 v2, 2, v0
    v_mul_u32_u24 v2, 288, v2
    v_lshrrev_b32 v3, 4, v0
    v_and_b32 v3, 2, v3
    v_and_b32 v4, 3, v0
    v_xor_b32 v3, v3, v4
    v_lshl_add_u32 v2, v3, 4, v2
    s_lshl_b32 s41, s29, 6
    v_add_u32 v10, s41, v2
    s_cmp_eq_u32 s29, 4
    s_cselect_b32 s41, 1, 100
    v_cmp_lt_u32 vcc, s41, v3
    s_mul_i32 s55, s33, 4608
    s_lshl_b32 s45, s33, 10
    s_mov_b32 s54, 61440
    v_cndmask_b32 v10, v10, v9, vcc

    s_mov_b32 s60, 0
L_ld0:
    s_add_u32 s57, s54, s45
    s_add_u32 m0, s57, 0
    s_add_u32 s58, s55, 0
    buffer_load_dwordx4 v10, s[12:15], s58 offen lds
    s_add_u32 s57, s54, s45
    s_add_u32 m0, s57, 4096
    s_add_u32 s58, s55, 18432
    buffer_load_dwordx4 v10, s[12:15], s58 offen lds
    s_add_u32 s57, s54, s45
    s_add_u32 m0, s57, 8192
    s_add_u32 s58, s55, 36864
    buffer_load_dwordx4 v10, s[12:15], s58 offen lds
    s_add_u32 s57, s54, s45
    s_add_u32 m0, s57, 12288
    s_add_u32 s58, s55, 55296
    buffer_load_dwordx4 v10, s[12:15], s58 offen lds
    s_cmp_ge_u32 s33, 2
    s_cbranch_scc1 L_w1skip_p
    s_add_u32 s57, s54, s45
    s_add_u32 m0, s57, 16384
    s_add_u32 s58, s55, 73728
    buffer_load_dwordx4 v10, s[12:15], s58 offen lds
L_w1skip_p:
    s_add_u32 s55, s55, 82944
    s_add_u32 s54, s54, 18432
    s_cmp_ge_u32 s54, 153600
    s_cselect_b32 s54, 61440, s54
    s_add_u32 s60, s60, 1
    s_cmp_lt_u32 s60, 4
    s_cbranch_scc1 L_ld0
    s_add_u32 s52, s33, 0
    s_cmp_ge_u32 s52, 9
    s_cselect_b32 s53, 9, 0
    s_cselect_b32 s46, 41472, 0
    s_sub_u32 s52, s52, s53
    s_lshl_b32 s52, s52, 6
    v_add_u32 v1, s52, v0
    v_mul_u32_u24 v2, 3641, v1
    v_lshrrev_b32 v2, 16, v2
    v_mul_u32_u24 v3, 18, v2
    v_sub_u32 v3, v1, v3
    v_and_b32 v4, 4, v2
    v_lshlrev_b32 v4, 1, v4
    v_and_b32 v5, 8, v2
    v_lshrrev_b32 v5, 1, v5
    v_or_b32 v4, v4, v5
    v_and_b32 v5, 0x13, v2
    v_or_b32 v4, v4, v5
    v_mul_u32_u24 v21, 288, v4
    v_lshl_add_u32 v21, v3, 4, v21
    s_cmp_eq_u32 s29, 4
    s_cselect_b32 s53, 15, 100
    v_cmp_lt_u32 vcc, s53, v4
    s_mul_i32 s53, s29, 9216
    v_add_u32 v4, s53, v21
    v_cndmask_b32 v11, v4, v9, vcc

    s_add_u32 s52, s33, 4
    s_cmp_ge_u32 s52, 9
    s_cselect_b32 s53, 9, 0
    s_cselect_b32 s47, 41472, 0
    s_sub_u32 s52, s52, s53
    s_lshl_b32 s52, s52, 6
    v_add_u32 v1, s52, v0
    v_mul_u32_u24 v2, 3641, v1
    v_lshrrev_b32 v2, 16, v2
    v_mul_u32_u24 v3, 18, v2
    v_sub_u32 v3, v1, v3
    v_and_b32 v4, 4, v2
    v_lshlrev_b32 v4, 1, v4
    v_and_b32 v5, 8, v2
    v_lshrrev_b32 v5, 1, v5
    v_or_b32 v4, v4, v5
    v_and_b32 v5, 0x13, v2
    v_or_b32 v4, v4, v5
    v_mul_u32_u24 v22, 288, v4
    v_lshl_add_u32 v22, v3, 4, v22
    s_cmp_eq_u32 s29, 4
    s_cselect_b32 s53, 15, 100
    v_cmp_lt_u32 vcc, s53, v4
    s_mul_i32 s53, s29, 9216
    v_add_u32 v4, s53, v22
    v_cndmask_b32 v12, v4, v9, vcc

    s_add_u32 s52, s33, 8
    s_cmp_ge_u32 s52, 9
    s_cselect_b32 s53, 9, 0
    s_cselect_b32 s48, 41472, 0
    s_sub_u32 s52, s52, s53
    s_lshl_b32 s52, s52, 6
    v_add_u32 v1, s52, v0
    v_mul_u32_u24 v2, 3641, v1
    v_lshrrev_b32 v2, 16, v2
    v_mul_u32_u24 v3, 18, v2
    v_sub_u32 v3, v1, v3
    v_and_b32 v4, 4, v2
    v_lshlrev_b32 v4, 1, v4
    v_and_b32 v5, 8, v2
    v_lshrrev_b32 v5, 1, v5
    v_or_b32 v4, v4, v5
    v_and_b32 v5, 0x13, v2
    v_or_b32 v4, v4, v5
    v_mul_u32_u24 v23, 288, v4
    v_lshl_add_u32 v23, v3, 4, v23
    s_cmp_eq_u32 s29, 4
    s_cselect_b32 s53, 15, 100
    v_cmp_lt_u32 vcc, s53, v4
    s_mul_i32 s53, s29, 9216
    v_add_u32 v4, s53, v23
    v_cndmask_b32 v13, v4, v9, vcc

    s_add_u32 s52, s33, 12
    s_cmp_ge_u32 s52, 9
    s_cselect_b32 s53, 9, 0
    s_cselect_b32 s49, 41472, 0
    s_sub_u32 s52, s52, s53
    s_lshl_b32 s52, s52, 6
    v_add_u32 v1, s52, v0
    v_mul_u32_u24 v2, 3641, v1
    v_lshrrev_b32 v2, 16, v2
    v_mul_u32_u24 v3, 18, v2
    v_sub_u32 v3, v1, v3
    v_and_b32 v4, 4, v2
    v_lshlrev_b32 v4, 1, v4
    v_and_b32 v5, 8, v2
    v_lshrrev_b32 v5, 1, v5
    v_or_b32 v4, v4, v5
    v_and_b32 v5, 0x13, v2
    v_or_b32 v4, v4, v5
    v_mul_u32_u24 v24, 288, v4
    v_lshl_add_u32 v24, v3, 4, v24
    s_cmp_eq_u32 s29, 4
    s_cselect_b32 s53, 15, 100
    v_cmp_lt_u32 vcc, s53, v4
    s_mul_i32 s53, s29, 9216
    v_add_u32 v4, s53, v24
    v_cndmask_b32 v14, v4, v9, vcc

    s_add_u32 s52, s33, 16
    s_cmp_ge_u32 s52, 9
    s_cselect_b32 s53, 9, 0
    s_cselect_b32 s50, 41472, 0
    s_sub_u32 s52, s52, s53
    s_lshl_b32 s52, s52, 6
    v_add_u32 v1, s52, v0
    v_mul_u32_u24 v2, 3641, v1
    v_lshrrev_b32 v2, 16, v2
    v_mul_u32_u24 v3, 18, v2
    v_sub_u32 v3, v1, v3
    v_and_b32 v4, 4, v2
    v_lshlrev_b32 v4, 1, v4
    v_and_b32 v5, 8, v2
    v_lshrrev_b32 v5, 1, v5
    v_or_b32 v4, v4, v5
    v_and_b32 v5, 0x13, v2
    v_or_b32 v4, v4, v5
    v_mul_u32_u24 v25, 288, v4
    v_lshl_add_u32 v25, v3, 4, v25
    s_cmp_eq_u32 s29, 4
    s_cselect_b32 s53, 15, 100
    v_cmp_lt_u32 vcc, s53, v4
    s_mul_i32 s53, s29, 9216
    v_add_u32 v4, s53, v25
    v_cndmask_b32 v15, v4, v9, vcc

    s_mov_b32 s56, 0
    s_cmp_ge_u32 s33, 1
    s_cselect_b32 s61, 9216, 0
    s_mov_b32 s60, 0
L_ld1:
    s_waitcnt vmcnt(12)
    s_barrier
    s_add_u32 s57, s54, s45
    s_add_u32 m0, s57, 0
    s_add_u32 s58, s55, 0
    buffer_load_dwordx4 v10, s[12:15], s58 offen lds
    s_add_u32 s57, s54, s45
    s_add_u32 m0, s57, 4096
    s_add_u32 s58, s55, 18432
    buffer_load_dwordx4 v10, s[12:15], s58 offen lds
    s_add_u32 s57, s54, s45
    s_add_u32 m0, s57, 8192
    s_add_u32 s58, s55, 36864
    buffer_load_dwordx4 v10, s[12:15], s58 offen lds
    s_add_u32 s57, s54, s45
    s_add_u32 m0, s57, 12288
    s_add_u32 s58, s55, 55296
    buffer_load_dwordx4 v10, s[12:15], s58 offen lds
    s_cmp_ge_u32 s33, 2
    s_cbranch_scc1 L_w1skip_l1
    s_add_u32 s57, s54, s45
    s_add_u32 m0, s57, 16384
    s_add_u32 s58, s55, 73728
    buffer_load_dwordx4 v10, s[12:15], s58 offen lds
L_w1skip_l1:
    s_add_u32 s55, s55, 82944
    s_add_u32 s54, s54, 18432
    s_cmp_ge_u32 s54, 153600
    s_cselect_b32 s54, 61440, s54
    s_add_u32 s60, s60, 1
    s_cmp_lt_u32 s60, 3
    s_cbranch_scc1 L_ld1
    s_waitcnt vmcnt(12)
    s_barrier
    s_add_u32 s57, s54, s45
    s_add_u32 m0, s57, 0
    s_add_u32 s58, s55, 0
    buffer_load_dwordx4 v10, s[12:15], s58 offen lds
    s_add_u32 s57, s54, s45
    s_add_u32 m0, s57, 4096
    s_add_u32 s58, s55, 18432
    buffer_load_dwordx4 v10, s[12:15], s58 offen lds
    s_cmp_ge_u32 s33, 2
    s_cbranch_scc1 L_w1skip_t
    s_add_u32 s57, s54, s45
    s_add_u32 m0, s57, 8192
    s_add_u32 s58, s55, 36864
    s_cmp_eq_u32 s33, 1
    s_cselect_b32 s59, 2147483648, 0
    v_or_b32 v16, s59, v10
    buffer_load_dwordx4 v16, s[12:15], s58 offen lds
L_w1skip_t:
    s_add_u32 s55, s55, 82944
    s_add_u32 s54, s54, 18432
    s_cmp_ge_u32 s54, 153600
    s_cselect_b32 s54, 61440, s54
    s_mov_b32 s60, 0
L_ld2:
    s_waitcnt vmcnt(10)
    s_barrier
    s_add_u32 s57, s54, s45
    s_add_u32 m0, s57, 0
    s_add_u32 s58, s56, s46
    buffer_load_dwordx4 v11, s[16:19], s58 offen lds
    s_add_u32 s57, s54, s45
    s_add_u32 m0, s57, 4096
    s_add_u32 s58, s56, s47
    buffer_load_dwordx4 v12, s[16:19], s58 offen lds
    s_add_u32 s57, s54, s45
    s_add_u32 m0, s57, 8192
    s_add_u32 s58, s56, s48
    buffer_load_dwordx4 v13, s[16:19], s58 offen lds
    s_add_u32 s57, s54, s45
    s_add_u32 m0, s57, 12288
    s_add_u32 s58, s56, s49
    buffer_load_dwordx4 v14, s[16:19], s58 offen lds
    s_cmp_ge_u32 s33, 2
    s_cbranch_scc1 L_w2skip_l2
    s_add_u32 s57, s54, s45
    s_add_u32 m0, s57, 16384
    s_add_u32 s58, s56, s50
    buffer_load_dwordx4 v15, s[16:19], s58 offen lds
L_w2skip_l2:
    s_add_u32 s56, s56, 82944
    s_add_u32 s54, s54, 18432
    s_cmp_ge_u32 s54, 153600
    s_cselect_b32 s54, 61440, s54
    s_add_u32 s60, s60, 1
    s_cmp_lt_u32 s60, 4
    s_cbranch_scc1 L_ld2
    s_barrier
    s_mov_b32 s60, 0
    s_mov_b32 s54, 0
L_ld3:
    s_add_u32 s57, s54, s45
    s_add_u32 m0, s57, 0
    s_add_u32 s58, s56, s46
    buffer_load_dwordx4 v11, s[16:19], s58 offen lds
    s_add_u32 s57, s54, s45
    s_add_u32 m0, s57, 4096
    s_add_u32 s58, s56, s47
    buffer_load_dwordx4 v12, s[16:19], s58 offen lds
    s_add_u32 s57, s54, s45
    s_add_u32 m0, s57, 8192
    s_add_u32 s58, s56, s48
    buffer_load_dwordx4 v13, s[16:19], s58 offen lds
    s_add_u32 s57, s54, s45
    s_add_u32 m0, s57, 12288
    s_add_u32 s58, s56, s49
    buffer_load_dwordx4 v14, s[16:19], s58 offen lds
    s_cmp_ge_u32 s33, 2
    s_cbranch_scc1 L_w2skip_l3
    s_add_u32 s57, s54, s45
    s_add_u32 m0, s57, 16384
    s_add_u32 s58, s56, s50
    buffer_load_dwordx4 v15, s[16:19], s58 offen lds
L_w2skip_l3:
    s_add_u32 s56, s56, 82944
    s_add_u32 s54, s54, 18432
    s_cmp_ge_u32 s54, 153600
    s_cselect_b32 s54, 61440, s54
    s_add_u32 s60, s60, 1
    s_cmp_lt_u32 s60, 2
    s_cbranch_scc1 L_ld3
    s_waitcnt vmcnt(8)
    s_barrier
    s_add_u32 s57, s54, s45
    s_add_u32 m0, s57, 0
    s_add_u32 s58, s56, s46
    buffer_load_dwordx4 v11, s[16:19], s58 offen lds
    s_add_u32 s57, s54, s45
    s_add_u32 m0, s57, 4096
    s_add_u32 s58, s56, s47
    buffer_load_dwordx4 v12, s[16:19], s58 offen lds
    s_add_u32 s57, s54, s45
    s_add_u32 m0, s57, 8192
    s_add_u32 s58, s56, s48
    buffer_load_dwordx4 v13, s[16:19], s58 offen lds
    s_add_u32 s57, s54, s45
    s_add_u32 m0, s57, 12288
    s_add_u32 s58, s56, s49
    buffer_load_dwordx4 v14, s[16:19], s58 offen lds
    s_cmp_ge_u32 s33, 2
    s_cbranch_scc1 L_w2skip_l4
    s_add_u32 s57, s54, s45
    s_add_u32 m0, s57, 16384
    s_add_u32 s58, s56, s50
    buffer_load_dwordx4 v15, s[16:19], s58 offen lds
L_w2skip_l4:
    s_add_u32 s56, s56, 82944
    s_add_u32 s54, s54, 18432
    s_cmp_ge_u32 s54, 153600
    s_cselect_b32 s54, 61440, s54
    s_mov_b32 s54, 98304
    s_add_u32 s57, s54, s45
    s_add_u32 m0, s57, 0
    s_add_u32 s58, s56, s46
    buffer_load_dwordx4 v11, s[16:19], s58 offen lds
    s_add_u32 s57, s54, s45
    s_add_u32 m0, s57, 4096
    s_add_u32 s58, s56, s47
    buffer_load_dwordx4 v12, s[16:19], s58 offen lds
    s_cmp_ge_u32 s33, 1
    s_cbranch_scc1 L_w2skip_t
    s_add_u32 s57, s54, s45
    s_add_u32 m0, s57, 8192
    s_add_u32 s58, s56, s48
    buffer_load_dwordx4 v13, s[16:19], s58 offen lds
L_w2skip_t:
    s_add_u32 s56, s56, 82944
    s_add_u32 s54, s54, 18432
    s_cmp_ge_u32 s54, 153600
    s_cselect_b32 s54, 61440, s54
    s_waitcnt vmcnt(6)
    s_barrier
    s_waitcnt vmcnt(0)
    s_barrier
    s_add_u32 s57, s45, 107520
    s_mov_b32 s58, 0
    s_add_u32 m0, s57, 0
    s_nop 0
    buffer_load_dwordx4 v21, s[64:67], s58 offen lds
    s_mov_b32 s58, 0
    s_add_u32 m0, s57, 4096
    s_nop 0
    buffer_load_dwordx4 v22, s[64:67], s58 offen lds
    s_add_u32 s58, s61, 0
    s_add_u32 m0, s57, 8192
    s_nop 0
    buffer_load_dwordx4 v23, s[64:67], s58 offen lds
    s_mov_b32 s58, 9216
    s_add_u32 m0, s57, 12288
    s_nop 0
    buffer_load_dwordx4 v24, s[64:67], s58 offen lds
    s_cmp_ge_u32 s33, 2
    s_cbranch_scc1 L_wd_wf_0
    s_mov_b32 s58, 9216
    s_add_u32 m0, s57, 16384
    s_nop 0
    buffer_load_dwordx4 v25, s[64:67], s58 offen lds
L_wd_wf_0:
    s_add_u32 s57, s45, 125952
    s_mov_b32 s58, 18432
    s_add_u32 m0, s57, 0
    s_nop 0
    buffer_load_dwordx4 v21, s[64:67], s58 offen lds
    s_mov_b32 s58, 18432
    s_add_u32 m0, s57, 4096
    s_nop 0
    buffer_load_dwordx4 v22, s[64:67], s58 offen lds
    s_add_u32 s58, s61, 18432
    s_add_u32 m0, s57, 8192
    s_nop 0
    buffer_load_dwordx4 v23, s[64:67], s58 offen lds
    s_mov_b32 s58, 27648
    s_add_u32 m0, s57, 12288
    s_nop 0
    buffer_load_dwordx4 v24, s[64:67], s58 offen lds
    s_cmp_ge_u32 s33, 2
    s_cbranch_scc1 L_wd_wf_1
    s_mov_b32 s58, 27648
    s_add_u32 m0, s57, 16384
    s_nop 0
    buffer_load_dwordx4 v25, s[64:67], s58 offen lds
L_wd_wf_1:
    s_add_u32 s57, s45, 144384
    v_add_u32 v1, 36864, v21
    v_add_u32 v2, 36864, v22
    s_mov_b32 m0, s57
    s_nop 0
    buffer_load_dwordx4 v1, s[64:67], 0 offen lds
    s_cmp_ge_u32 s33, 1
    s_cbranch_scc1 L_wd_wf_t
    s_add_u32 m0, s57, 4096
    s_nop 0
    buffer_load_dwordx4 v2, s[64:67], 0 offen lds
L_wd_wf_t:

    s_add_u32 s57, s45, 55296
    s_mov_b32 s58, 0
    s_add_u32 m0, s57, 0
    s_nop 0
    buffer_load_dwordx4 v21, s[68:71], s58 offen lds
    s_mov_b32 s58, 0
    s_add_u32 m0, s57, 4096
    s_nop 0
    buffer_load_dwordx4 v22, s[68:71], s58 offen lds
    s_add_u32 s58, s61, 0
    s_add_u32 m0, s57, 8192
    s_nop 0
    buffer_load_dwordx4 v23, s[68:71], s58 offen lds
    s_mov_b32 s58, 9216
    s_add_u32 m0, s57, 12288
    s_nop 0
    buffer_load_dwordx4 v24, s[68:71], s58 offen lds
    s_cmp_ge_u32 s33, 2
    s_cbranch_scc1 L_wd_wo_0
    s_mov_b32 s58, 9216
    s_add_u32 m0, s57, 16384
    s_nop 0
    buffer_load_dwordx4 v25, s[68:71], s58 offen lds
L_wd_wo_0:
    s_add_u32 s57, s45, 73728
    s_mov_b32 s58, 18432
    s_add_u32 m0, s57, 0
    s_nop 0
    buffer_load_dwordx4 v21, s[68:71], s58 offen lds
    s_mov_b32 s58, 18432
    s_add_u32 m0, s57, 4096
    s_nop 0
    buffer_load_dwordx4 v22, s[68:71], s58 offen lds
    s_add_u32 s58, s61, 18432
    s_add_u32 m0, s57, 8192
    s_nop 0
    buffer_load_dwordx4 v23, s[68:71], s58 offen lds
    s_mov_b32 s58, 27648
    s_add_u32 m0, s57, 12288
    s_nop 0
    buffer_load_dwordx4 v24, s[68:71], s58 offen lds
    s_cmp_ge_u32 s33, 2
    s_cbranch_scc1 L_wd_wo_1
    s_mov_b32 s58, 27648
    s_add_u32 m0, s57, 16384
    s_nop 0
    buffer_load_dwordx4 v25, s[68:71], s58 offen lds
L_wd_wo_1:
    s_add_u32 s57, s45, 92160
    v_add_u32 v1, 36864, v21
    v_add_u32 v2, 36864, v22
    s_mov_b32 m0, s57
    s_nop 0
    buffer_load_dwordx4 v1, s[68:71], 0 offen lds
    s_cmp_ge_u32 s33, 1
    s_cbranch_scc1 L_wd_wo_t
    s_add_u32 m0, s57, 4096
    s_nop 0
    buffer_load_dwordx4 v2, s[68:71], 0 offen lds
L_wd_wo_t:

    s_add_u32 s39, s30, 50
    s_lshl_b32 s39, s39, 2
    v_mov_b32 v26, s39
    s_cmp_lg_u32 s32, 7
    s_cbranch_scc1 L_nogc
    buffer_load_dword v27, v26, s[76:79], 0 offen sc1
L_nogc:
    s_cmp_lg_u32 s32, 7
    s_cbranch_scc1 L_gc_done
    s_mov_b32 s40, 0
L_gc:
    s_waitcnt vmcnt(0)
    v_cmp_gt_u32 vcc, 1, v27
    s_add_u32 s40, s40, 1
    s_nop 0
    s_cmp_eq_u64 vcc, 0
    s_cbranch_scc1 L_gc_done
    s_cmp_ge_u32 s40, 400000
    s_cbranch_scc1 L_gc_done
    buffer_load_dword v27, v26, s[76:79], 0 offen sc1
    s_branch L_gc
L_gc_done:

L_k2:
    v_lshrrev_b32 v10, 5, v0
    v_lshlrev_b32 v10, 4, v10
    v_bfe_u32 v11, v0, 4, 1
    v_lshl_add_u32 v10, v11, 2, v10
    v_bfe_u32 v11, v0, 2, 2
    v_add_u32 v10, v10, v11
    v_mul_u32_u24 v10, 288, v10
    v_and_b32 v11, 3, v0
    v_lshl_add_u32 v4, v11, 3, v10

    v_bfe_u32 v10, v0, 4, 1
    v_lshlrev_b32 v10, 1, v10
    v_bfe_u32 v11, v0, 5, 1
    v_or_b32 v10, v10, v11
    v_bfe_u32 v11, v0, 2, 2
    v_lshl_add_u32 v10, v10, 2, v11
    v_add_u32 v10, 128, v10
    v_mul_u32_u24 v10, 288, v10
    v_and_b32 v11, 3, v0
    v_lshl_add_u32 v5, v11, 3, v10

    v_and_b32 v1, 15, v0
    v_lshrrev_b32 v2, 4, v0
    v_mul_u32_u24 v6, 288, v1
    v_add_u32 v6, 0, v6
    v_lshl_add_u32 v7, v2, 3, v6
    v_add_u32 v7, 256, v7
    v_lshl_add_u32 v6, v2, 4, v6
    s_lshl_b32 s39, s32, 5
    s_add_u32 s39, s39, 107520
    v_add_u32 v14, s39, v4
    v_add_u32 v15, s39, v5
    v_mul_u32_u24 v8, 576, v1
    v_lshl_add_u32 v8, v2, 4, v8
    s_lshl_b32 s41, s32, 6
    s_add_u32 s41, s41, 4608
    v_add_u32 v8, s41, v8
    s_mov_b32 s44, 1077455419

    s_lshl_b32 s39, s32, 6
    v_add_u32 v77, s39, v0
    s_mul_i32 s40, s28, 5
    s_add_u32 s40, s40, s29
    s_mul_i32 s40, s40, 11520
    s_add_u32 s40, s40, 0
    v_lshl_add_u32 v78, v77, 3, s40
    v_mov_b32 v9, 2147483648
    s_movk_i32 s41, 288
    v_cmp_gt_u32 vcc, s41, v77
    s_movk_i32 s42, 4608
    s_movk_i32 s43, 9216
    v_cndmask_b32 v78, v9, v78, vcc

    v_lshrrev_b32 v10, 5, v77
    v_lshlrev_b32 v10, 5, v10
    v_bfe_u32 v11, v77, 3, 2
    v_lshl_add_u32 v10, v11, 3, v10
    v_and_b32 v11, 7, v77
    v_mul_u32_u24 v11, 288, v11
    v_add_u32 v10, v10, v11
    v_add_u32 v10, 0, v10
    v_mov_b32 v11, 4320
    v_cndmask_b32 v10, v11, v10, vcc
    s_mov_b32 s40, 3222493025
    v_mov_b32 v12, 3184710632
    v_mov_b32 v13, 0xffff0000

    v_and_b32 v74, 7, v0
    v_mul_u32_u24 v74, 576, v74
    v_lshrrev_b32 v76, 4, v0
    s_mul_i32 s39, s30, 4608
    s_add_u32 s39, s39, 3145728
    v_add_u32 v74, s39, v74
    v_lshl_add_u32 v75, v76, 4, v74
    v_lshl_add_u32 v74, v76, 5, v74

    s_cmp_lg_u32 s32, 4
    s_cbranch_scc1 L_poll_done
    s_mul_i32 s58, s28, 640
    s_lshl_b32 s59, s29, 7
    s_add_u32 s58, s58, s59
    s_add_u32 s58, s58, 3670016
    v_min_u32 v79, 19, v0
    v_lshl_add_u32 v79, v79, 2, s58
    s_mov_b32 s59, 0
L_poll:
    buffer_load_dword v80, v79, s[20:23], 0 offen sc1
    s_add_u32 s59, s59, 1
    s_cmp_ge_u32 s59, 400000
    s_cbranch_scc1 L_poll_done
    s_waitcnt vmcnt(0)
    v_cmp_ne_u32 vcc, 1, v80
    s_nop 1
    s_cmp_lg_u64 vcc, 0
    s_cbranch_scc1 L_poll
L_poll_done:

    s_barrier
    s_cmp_ge_u32 s32, 5
    s_cbranch_scc1 L_k2_nosum
    buffer_load_dwordx2 v[52:53], v78, s[20:23], 0 offen offset:0 sc1
    buffer_load_dwordx2 v[54:55], v78, s[20:23], 0 offen offset:2304 sc1
    buffer_load_dwordx2 v[56:57], v78, s[20:23], s42 offen offset:0 sc1
    buffer_load_dwordx2 v[58:59], v78, s[20:23], s42 offen offset:2304 sc1
    buffer_load_dwordx2 v[60:61], v78, s[20:23], s43 offen offset:0 sc1
    s_cmp_ge_u32 s32, 4
    s_cbranch_scc1 L_k2_noge
    buffer_load_dwordx4 v[16:19], v74, s[20:23], 0 offen offset:0
    buffer_load_dwordx4 v[20:23], v74, s[20:23], 0 offen offset:16
    buffer_load_dwordx4 v[24:27], v74, s[20:23], 0 offen offset:128
    buffer_load_dwordx4 v[28:31], v74, s[20:23], 0 offen offset:144
    buffer_load_dwordx4 v[32:35], v74, s[20:23], 0 offen offset:256
    buffer_load_dwordx4 v[36:39], v74, s[20:23], 0 offen offset:272
    buffer_load_dwordx4 v[40:43], v74, s[20:23], 0 offen offset:384
    buffer_load_dwordx4 v[44:47], v74, s[20:23], 0 offen offset:400
    buffer_load_dwordx4 v[48:51], v75, s[20:23], 0 offen offset:512
L_k2_noge:
    s_cmp_ge_u32 s32, 4
    s_cbranch_scc1 L_k2_w4
    s_waitcnt vmcnt(9)
    s_branch L_k2_go
L_k2_w4:
    s_waitcnt vmcnt(0)
L_k2_go:
    v_lshlrev_b32 v64, 16, v52
    v_and_b32 v65, v13, v52
    v_lshlrev_b32 v66, 16, v53
    v_and_b32 v67, v13, v53
    v_lshlrev_b32 v68, 16, v54
    v_and_b32 v69, v13, v54
    v_lshlrev_b32 v70, 16, v55
    v_and_b32 v71, v13, v55
    v_pk_add_f32 v[64:65], v[64:65], v[68:69]
    v_pk_add_f32 v[66:67], v[66:67], v[70:71]
    v_lshlrev_b32 v68, 16, v56
    v_and_b32 v69, v13, v56
    v_lshlrev_b32 v70, 16, v57
    v_and_b32 v71, v13, v57
    v_pk_add_f32 v[64:65], v[64:65], v[68:69]
    v_pk_add_f32 v[66:67], v[66:67], v[70:71]
    v_lshlrev_b32 v68, 16, v58
    v_and_b32 v69, v13, v58
    v_lshlrev_b32 v70, 16, v59
    v_and_b32 v71, v13, v59
    v_pk_add_f32 v[64:65], v[64:65], v[68:69]
    v_pk_add_f32 v[66:67], v[66:67], v[70:71]
    v_lshlrev_b32 v68, 16, v60
    v_and_b32 v69, v13, v60
    v_lshlrev_b32 v70, 16, v61
    v_and_b32 v71, v13, v61
    v_pk_add_f32 v[64:65], v[64:65], v[68:69]
    v_pk_add_f32 v[66:67], v[66:67], v[70:71]
    v_mul_f32 v68, v64, v64
    v_mul_f32 v69, v65, v65
    v_mul_f32 v70, v66, v66
    v_mul_f32 v71, v67, v67
    v_fma_f32 v68, v68, v12, s40
    v_fma_f32 v69, v69, v12, s40
    v_fma_f32 v70, v70, v12, s40
    v_fma_f32 v71, v71, v12, s40
    v_mul_f32 v68, v68, v64
    v_mul_f32 v69, v69, v65
    v_mul_f32 v70, v70, v66
    v_mul_f32 v71, v71, v67
    v_exp_f32 v68, v68
    v_exp_f32 v69, v69
    v_exp_f32 v70, v70
    v_exp_f32 v71, v71
    v_add_f32 v68, 1.0, v68
    v_add_f32 v69, 1.0, v69
    v_add_f32 v70, 1.0, v70
    v_add_f32 v71, 1.0, v71
    v_rcp_f32 v68, v68
    v_rcp_f32 v69, v69
    v_rcp_f32 v70, v70
    v_rcp_f32 v71, v71
    v_mul_f32 v64, v64, v68
    v_mul_f32 v65, v65, v69
    v_mul_f32 v66, v66, v70
    v_mul_f32 v67, v67, v71
    v_cvt_pk_bf16_f32 v72, v64, v65
    v_cvt_pk_bf16_f32 v73, v66, v67
    ds_write_b64 v10, v[72:73]
L_k2_nosum:
    s_cmp_lt_u32 s32, 4
    s_cbranch_scc1 L_k2_nw
    s_waitcnt vmcnt(0)
L_k2_nw:
    s_waitcnt lgkmcnt(0)
    s_barrier
    ds_read_b128 v[64:67], v6 offset:0
    ds_read_b128 v[68:71], v6 offset:64
    ds_read_b128 v[72:75], v6 offset:128
    ds_read_b128 v[76:79], v6 offset:192
    ds_read_b64 v[80:81], v7
    ds_read_b64_tr_b16 v[92:93], v14 offset:0
    ds_read_b64_tr_b16 v[94:95], v14 offset:2304
    ds_read_b64_tr_b16 v[96:97], v14 offset:9216
    ds_read_b64_tr_b16 v[98:99], v14 offset:11520
    ds_read_b64_tr_b16 v[100:101], v14 offset:18432
    ds_read_b64_tr_b16 v[102:103], v14 offset:20736
    ds_read_b64_tr_b16 v[104:105], v14 offset:27648
    ds_read_b64_tr_b16 v[106:107], v14 offset:29952
    ds_read_b64_tr_b16 v[108:109], v15 offset:0
    s_waitcnt lgkmcnt(7)
    v_mfma_f32_16x16x32_bf16 v[84:87], v[92:95], v[64:67], 0
    s_waitcnt lgkmcnt(5)
    v_mfma_f32_16x16x32_bf16 v[84:87], v[96:99], v[68:71], v[84:87]
    s_waitcnt lgkmcnt(3)
    v_mfma_f32_16x16x32_bf16 v[84:87], v[100:103], v[72:75], v[84:87]
    s_waitcnt lgkmcnt(1)
    v_mfma_f32_16x16x32_bf16 v[84:87], v[104:107], v[76:79], v[84:87]
    s_waitcnt lgkmcnt(0)
    s_nop 7
    v_mfma_f32_16x16x16_bf16 v[84:87], v[108:109], v[80:81], v[84:87]
    s_nop 7
    v_mul_f32 v88, s44, v84
    v_mul_f32 v89, s44, v85
    v_mul_f32 v90, s44, v86
    v_mul_f32 v91, s44, v87
    ds_write_b128 v8, v[88:91] offset:0
    s_cmp_lg_u32 s32, 7
    s_cbranch_scc1 L_fe_done
    ds_read_b64_tr_b16 v[92:93], v14 offset:32
    ds_read_b64_tr_b16 v[94:95], v14 offset:2336
    ds_read_b64_tr_b16 v[96:97], v14 offset:9248
    ds_read_b64_tr_b16 v[98:99], v14 offset:11552
    ds_read_b64_tr_b16 v[100:101], v14 offset:18464
    ds_read_b64_tr_b16 v[102:103], v14 offset:20768
    ds_read_b64_tr_b16 v[104:105], v14 offset:27680
    ds_read_b64_tr_b16 v[106:107], v14 offset:29984
    ds_read_b64_tr_b16 v[108:109], v15 offset:32
    s_waitcnt lgkmcnt(7)
    v_mfma_f32_16x16x32_bf16 v[84:87], v[92:95], v[64:67], 0
    s_waitcnt lgkmcnt(5)
    v_mfma_f32_16x16x32_bf16 v[84:87], v[96:99], v[68:71], v[84:87]
    s_waitcnt lgkmcnt(3)
    v_mfma_f32_16x16x32_bf16 v[84:87], v[100:103], v[72:75], v[84:87]
    s_waitcnt lgkmcnt(1)
    v_mfma_f32_16x16x32_bf16 v[84:87], v[104:107], v[76:79], v[84:87]
    s_waitcnt lgkmcnt(0)
    s_nop 7
    v_mfma_f32_16x16x16_bf16 v[84:87], v[108:109], v[80:81], v[84:87]
    s_nop 7
    v_mul_f32 v88, s44, v84
    v_mul_f32 v89, s44, v85
    v_mul_f32 v90, s44, v86
    v_mul_f32 v91, s44, v87
    ds_write_b128 v8, v[88:91] offset:64
L_fe_done:
    s_waitcnt lgkmcnt(0)
    s_barrier
    s_cmp_ge_u32 s32, 4
    s_cbranch_scc1 L_k1_end
    v_lshrrev_b32 v6, 3, v1
    s_lshl_b32 s39, s32, 1
    v_add_u32 v6, s39, v6
    v_mul_u32_u24 v6, 576, v6
    v_add_u32 v6, 4608, v6
    v_lshl_add_u32 v7, v2, 4, v6
    v_lshl_add_u32 v6, v2, 5, v6
    v_add_u32 v4, 55296, v4
    v_add_u32 v5, 55296, v5

    ds_read_b128 v[160:163], v6 offset:0
    ds_read_b128 v[164:167], v6 offset:16
    ds_read_b128 v[168:171], v6 offset:128
    ds_read_b128 v[172:175], v6 offset:144
    ds_read_b128 v[176:179], v6 offset:256
    ds_read_b128 v[180:183], v6 offset:272
    ds_read_b128 v[184:187], v6 offset:384
    ds_read_b128 v[188:191], v6 offset:400
    ds_read_b128 v[192:195], v7 offset:512
    s_mov_b32 s46, 0xc0000000
    s_mov_b32 s47, 0xc0000000
    s_mul_i32 s39, s30, 1000
    s_mul_i32 s40, s31, 40
    s_add_u32 s39, s39, s40
    s_lshl_b32 s40, s29, 3
    s_add_u32 s39, s39, s40
    s_lshl_b32 s40, s32, 1
    s_add_u32 s39, s39, s40
    s_mul_i32 s39, s39, 2304
    v_mul_u32_u24 v8, 288, v1
    v_add_u32 v8, s39, v8
    v_lshl_add_u32 v9, v2, 3, v8
    v_and_b32 v10, 1, v2
    v_lshl_add_u32 v8, v10, 5, v8
    v_lshrrev_b32 v10, 1, v2
    v_lshl_add_u32 v8, v10, 4, v8
    s_waitcnt vmcnt(0) lgkmcnt(0)

    v_pk_add_f32 v[16:17], v[16:17], v[160:161]
    v_pk_add_f32 v[18:19], v[18:19], v[162:163]
    v_pk_add_f32 v[20:21], v[20:21], v[164:165]
    v_pk_add_f32 v[22:23], v[22:23], v[166:167]
    v_pk_add_f32 v[24:25], v[24:25], v[168:169]
    v_pk_add_f32 v[26:27], v[26:27], v[170:171]
    v_pk_add_f32 v[28:29], v[28:29], v[172:173]
    v_pk_add_f32 v[30:31], v[30:31], v[174:175]
    v_pk_add_f32 v[32:33], v[32:33], v[176:177]
    v_pk_add_f32 v[34:35], v[34:35], v[178:179]
    v_pk_add_f32 v[36:37], v[36:37], v[180:181]
    v_pk_add_f32 v[38:39], v[38:39], v[182:183]
    v_pk_add_f32 v[40:41], v[40:41], v[184:185]
    v_pk_add_f32 v[42:43], v[42:43], v[186:187]
    v_pk_add_f32 v[44:45], v[44:45], v[188:189]
    v_pk_add_f32 v[46:47], v[46:47], v[190:191]
    v_pk_add_f32 v[48:49], v[48:49], v[192:193]
    v_pk_add_f32 v[50:51], v[50:51], v[194:195]
    ds_read_b64_tr_b16 v[88:89], v4 offset:0
    ds_read_b64_tr_b16 v[90:91], v4 offset:2304
    ds_read_b64_tr_b16 v[92:93], v4 offset:32
    ds_read_b64_tr_b16 v[94:95], v4 offset:2336
    ds_read_b64_tr_b16 v[96:97], v4 offset:64
    ds_read_b64_tr_b16 v[98:99], v4 offset:2368
    ds_read_b64_tr_b16 v[100:101], v4 offset:96
    ds_read_b64_tr_b16 v[102:103], v4 offset:2400
    ds_read_b64_tr_b16 v[104:105], v4 offset:128
    ds_read_b64_tr_b16 v[106:107], v4 offset:2432
    ds_read_b64_tr_b16 v[108:109], v4 offset:160
    ds_read_b64_tr_b16 v[110:111], v4 offset:2464
    ds_read_b64_tr_b16 v[112:113], v4 offset:192
    ds_read_b64_tr_b16 v[114:115], v4 offset:2496
    ds_read_b64_tr_b16 v[116:117], v4 offset:224
    v_exp_f32 v16, v16
    v_exp_f32 v17, v17
    ds_read_b64_tr_b16 v[118:119], v4 offset:2528
    v_exp_f32 v18, v18
    v_exp_f32 v19, v19
    ds_read_b64_tr_b16 v[120:121], v4 offset:256
    v_exp_f32 v20, v20
    v_exp_f32 v21, v21
    ds_read_b64_tr_b16 v[122:123], v4 offset:2560
    v_exp_f32 v22, v22
    v_exp_f32 v23, v23
    v_pk_add_f32 v[16:17], v[16:17], 1.0 op_sel_hi:[1,0]
    v_pk_add_f32 v[18:19], v[18:19], 1.0 op_sel_hi:[1,0]
    v_pk_add_f32 v[20:21], v[20:21], 1.0 op_sel_hi:[1,0]
    v_pk_add_f32 v[22:23], v[22:23], 1.0 op_sel_hi:[1,0]
    v_rcp_f32 v16, v16
    v_rcp_f32 v17, v17
    v_rcp_f32 v18, v18
    v_rcp_f32 v19, v19
    v_rcp_f32 v20, v20
    v_rcp_f32 v21, v21
    v_rcp_f32 v22, v22
    v_rcp_f32 v23, v23
    v_pk_fma_f32 v[16:17], v[16:17], s[46:47], 1.0 op_sel_hi:[1,1,0]
    v_pk_fma_f32 v[18:19], v[18:19], s[46:47], 1.0 op_sel_hi:[1,1,0]
    v_pk_fma_f32 v[20:21], v[20:21], s[46:47], 1.0 op_sel_hi:[1,1,0]
    v_pk_fma_f32 v[22:23], v[22:23], s[46:47], 1.0 op_sel_hi:[1,1,0]
    v_cvt_pk_bf16_f32 v196, v16, v17
    v_cvt_pk_bf16_f32 v197, v18, v19
    v_cvt_pk_bf16_f32 v198, v20, v21
    v_cvt_pk_bf16_f32 v199, v22, v23
    s_waitcnt lgkmcnt(0)
    ds_read_b64_tr_b16 v[124:125], v4 offset:9216
    ds_read_b64_tr_b16 v[126:127], v4 offset:11520
    ds_read_b64_tr_b16 v[128:129], v4 offset:9248
    ds_read_b64_tr_b16 v[130:131], v4 offset:11552
    ds_read_b64_tr_b16 v[132:133], v4 offset:9280
    ds_read_b64_tr_b16 v[134:135], v4 offset:11584
    ds_read_b64_tr_b16 v[136:137], v4 offset:9312
    ds_read_b64_tr_b16 v[138:139], v4 offset:11616
    ds_read_b64_tr_b16 v[140:141], v4 offset:9344
    ds_read_b64_tr_b16 v[142:143], v4 offset:11648
    ds_read_b64_tr_b16 v[144:145], v4 offset:9376
    ds_read_b64_tr_b16 v[146:147], v4 offset:11680
    ds_read_b64_tr_b16 v[148:149], v4 offset:9408
    ds_read_b64_tr_b16 v[150:151], v4 offset:11712
    ds_read_b64_tr_b16 v[152:153], v4 offset:9440
    v_exp_f32 v24, v24
    v_exp_f32 v25, v25
    ds_read_b64_tr_b16 v[154:155], v4 offset:11744
    v_mfma_f32_16x16x32_bf16 v[52:55], v[88:91], v[196:199], 0
    v_exp_f32 v26, v26
    v_exp_f32 v27, v27
    ds_read_b64_tr_b16 v[156:157], v4 offset:9472
    v_mfma_f32_16x16x32_bf16 v[56:59], v[92:95], v[196:199], 0
    v_exp_f32 v28, v28
    v_exp_f32 v29, v29
    ds_read_b64_tr_b16 v[158:159], v4 offset:11776
    v_mfma_f32_16x16x32_bf16 v[60:63], v[96:99], v[196:199], 0
    v_exp_f32 v30, v30
    v_exp_f32 v31, v31
    v_pk_add_f32 v[24:25], v[24:25], 1.0 op_sel_hi:[1,0]
    v_mfma_f32_16x16x32_bf16 v[64:67], v[100:103], v[196:199], 0
    v_pk_add_f32 v[26:27], v[26:27], 1.0 op_sel_hi:[1,0]
    v_pk_add_f32 v[28:29], v[28:29], 1.0 op_sel_hi:[1,0]
    v_pk_add_f32 v[30:31], v[30:31], 1.0 op_sel_hi:[1,0]
    v_mfma_f32_16x16x32_bf16 v[68:71], v[104:107], v[196:199], 0
    v_rcp_f32 v24, v24
    v_rcp_f32 v25, v25
    v_rcp_f32 v26, v26
    v_mfma_f32_16x16x32_bf16 v[72:75], v[108:111], v[196:199], 0
    v_rcp_f32 v27, v27
    v_rcp_f32 v28, v28
    v_rcp_f32 v29, v29
    v_mfma_f32_16x16x32_bf16 v[76:79], v[112:115], v[196:199], 0
    v_rcp_f32 v30, v30
    v_rcp_f32 v31, v31
    v_pk_fma_f32 v[24:25], v[24:25], s[46:47], 1.0 op_sel_hi:[1,1,0]
    v_mfma_f32_16x16x32_bf16 v[80:83], v[116:119], v[196:199], 0
    v_pk_fma_f32 v[26:27], v[26:27], s[46:47], 1.0 op_sel_hi:[1,1,0]
    v_pk_fma_f32 v[28:29], v[28:29], s[46:47], 1.0 op_sel_hi:[1,1,0]
    v_pk_fma_f32 v[30:31], v[30:31], s[46:47], 1.0 op_sel_hi:[1,1,0]
    v_mfma_f32_16x16x32_bf16 v[84:87], v[120:123], v[196:199], 0
    v_cvt_pk_bf16_f32 v200, v24, v25
    v_cvt_pk_bf16_f32 v201, v26, v27
    v_cvt_pk_bf16_f32 v202, v28, v29
    v_cvt_pk_bf16_f32 v203, v30, v31
    s_waitcnt lgkmcnt(0)
    ds_read_b64_tr_b16 v[88:89], v4 offset:18432
    ds_read_b64_tr_b16 v[90:91], v4 offset:20736
    ds_read_b64_tr_b16 v[92:93], v4 offset:18464
    ds_read_b64_tr_b16 v[94:95], v4 offset:20768
    ds_read_b64_tr_b16 v[96:97], v4 offset:18496
    ds_read_b64_tr_b16 v[98:99], v4 offset:20800
    ds_read_b64_tr_b16 v[100:101], v4 offset:18528
    ds_read_b64_tr_b16 v[102:103], v4 offset:20832
    ds_read_b64_tr_b16 v[104:105], v4 offset:18560
    ds_read_b64_tr_b16 v[106:107], v4 offset:20864
    ds_read_b64_tr_b16 v[108:109], v4 offset:18592
    ds_read_b64_tr_b16 v[110:111], v4 offset:20896
    ds_read_b64_tr_b16 v[112:113], v4 offset:18624
    ds_read_b64_tr_b16 v[114:115], v4 offset:20928
    ds_read_b64_tr_b16 v[116:117], v4 offset:18656
    v_exp_f32 v32, v32
    v_exp_f32 v33, v33
    ds_read_b64_tr_b16 v[118:119], v4 offset:20960
    v_mfma_f32_16x16x32_bf16 v[52:55], v[124:127], v[200:203], v[52:55]
    v_exp_f32 v34, v34
    v_exp_f32 v35, v35
    ds_read_b64_tr_b16 v[120:121], v4 offset:18688
    v_mfma_f32_16x16x32_bf16 v[56:59], v[128:131], v[200:203], v[56:59]
    v_exp_f32 v36, v36
    v_exp_f32 v37, v37
    ds_read_b64_tr_b16 v[122:123], v4 offset:20992
    v_mfma_f32_16x16x32_bf16 v[60:63], v[132:135], v[200:203], v[60:63]
    v_exp_f32 v38, v38
    v_exp_f32 v39, v39
    v_pk_add_f32 v[32:33], v[32:33], 1.0 op_sel_hi:[1,0]
    v_mfma_f32_16x16x32_bf16 v[64:67], v[136:139], v[200:203], v[64:67]
    v_pk_add_f32 v[34:35], v[34:35], 1.0 op_sel_hi:[1,0]
    v_pk_add_f32 v[36:37], v[36:37], 1.0 op_sel_hi:[1,0]
    v_pk_add_f32 v[38:39], v[38:39], 1.0 op_sel_hi:[1,0]
    v_mfma_f32_16x16x32_bf16 v[68:71], v[140:143], v[200:203], v[68:71]
    v_rcp_f32 v32, v32
    v_rcp_f32 v33, v33
    v_rcp_f32 v34, v34
    v_mfma_f32_16x16x32_bf16 v[72:75], v[144:147], v[200:203], v[72:75]
    v_rcp_f32 v35, v35
    v_rcp_f32 v36, v36
    v_rcp_f32 v37, v37
    v_mfma_f32_16x16x32_bf16 v[76:79], v[148:151], v[200:203], v[76:79]
    v_rcp_f32 v38, v38
    v_rcp_f32 v39, v39
    v_pk_fma_f32 v[32:33], v[32:33], s[46:47], 1.0 op_sel_hi:[1,1,0]
    v_mfma_f32_16x16x32_bf16 v[80:83], v[152:155], v[200:203], v[80:83]
    v_pk_fma_f32 v[34:35], v[34:35], s[46:47], 1.0 op_sel_hi:[1,1,0]
    v_pk_fma_f32 v[36:37], v[36:37], s[46:47], 1.0 op_sel_hi:[1,1,0]
    v_pk_fma_f32 v[38:39], v[38:39], s[46:47], 1.0 op_sel_hi:[1,1,0]
    v_mfma_f32_16x16x32_bf16 v[84:87], v[156:159], v[200:203], v[84:87]
    v_cvt_pk_bf16_f32 v196, v32, v33
    v_cvt_pk_bf16_f32 v197, v34, v35
    v_cvt_pk_bf16_f32 v198, v36, v37
    v_cvt_pk_bf16_f32 v199, v38, v39
    s_waitcnt lgkmcnt(0)
    ds_read_b64_tr_b16 v[124:125], v4 offset:27648
    ds_read_b64_tr_b16 v[126:127], v4 offset:29952
    ds_read_b64_tr_b16 v[128:129], v4 offset:27680
    ds_read_b64_tr_b16 v[130:131], v4 offset:29984
    ds_read_b64_tr_b16 v[132:133], v4 offset:27712
    ds_read_b64_tr_b16 v[134:135], v4 offset:30016
    ds_read_b64_tr_b16 v[136:137], v4 offset:27744
    ds_read_b64_tr_b16 v[138:139], v4 offset:30048
    ds_read_b64_tr_b16 v[140:141], v4 offset:27776
    ds_read_b64_tr_b16 v[142:143], v4 offset:30080
    ds_read_b64_tr_b16 v[144:145], v4 offset:27808
    ds_read_b64_tr_b16 v[146:147], v4 offset:30112
    ds_read_b64_tr_b16 v[148:149], v4 offset:27840
    ds_read_b64_tr_b16 v[150:151], v4 offset:30144
    ds_read_b64_tr_b16 v[152:153], v4 offset:27872
    v_exp_f32 v40, v40
    v_exp_f32 v41, v41
    ds_read_b64_tr_b16 v[154:155], v4 offset:30176
    v_mfma_f32_16x16x32_bf16 v[52:55], v[88:91], v[196:199], v[52:55]
    v_exp_f32 v42, v42
    v_exp_f32 v43, v43
    ds_read_b64_tr_b16 v[156:157], v4 offset:27904
    v_mfma_f32_16x16x32_bf16 v[56:59], v[92:95], v[196:199], v[56:59]
    v_exp_f32 v44, v44
    v_exp_f32 v45, v45
    ds_read_b64_tr_b16 v[158:159], v4 offset:30208
    v_mfma_f32_16x16x32_bf16 v[60:63], v[96:99], v[196:199], v[60:63]
    v_exp_f32 v46, v46
    v_exp_f32 v47, v47
    v_pk_add_f32 v[40:41], v[40:41], 1.0 op_sel_hi:[1,0]
    v_mfma_f32_16x16x32_bf16 v[64:67], v[100:103], v[196:199], v[64:67]
    v_pk_add_f32 v[42:43], v[42:43], 1.0 op_sel_hi:[1,0]
    v_pk_add_f32 v[44:45], v[44:45], 1.0 op_sel_hi:[1,0]
    v_pk_add_f32 v[46:47], v[46:47], 1.0 op_sel_hi:[1,0]
    v_mfma_f32_16x16x32_bf16 v[68:71], v[104:107], v[196:199], v[68:71]
    v_rcp_f32 v40, v40
    v_rcp_f32 v41, v41
    v_rcp_f32 v42, v42
    v_mfma_f32_16x16x32_bf16 v[72:75], v[108:111], v[196:199], v[72:75]
    v_rcp_f32 v43, v43
    v_rcp_f32 v44, v44
    v_rcp_f32 v45, v45
    v_mfma_f32_16x16x32_bf16 v[76:79], v[112:115], v[196:199], v[76:79]
    v_rcp_f32 v46, v46
    v_rcp_f32 v47, v47
    v_pk_fma_f32 v[40:41], v[40:41], s[46:47], 1.0 op_sel_hi:[1,1,0]
    v_mfma_f32_16x16x32_bf16 v[80:83], v[116:119], v[196:199], v[80:83]
    v_pk_fma_f32 v[42:43], v[42:43], s[46:47], 1.0 op_sel_hi:[1,1,0]
    v_pk_fma_f32 v[44:45], v[44:45], s[46:47], 1.0 op_sel_hi:[1,1,0]
    v_pk_fma_f32 v[46:47], v[46:47], s[46:47], 1.0 op_sel_hi:[1,1,0]
    v_mfma_f32_16x16x32_bf16 v[84:87], v[120:123], v[196:199], v[84:87]
    v_cvt_pk_bf16_f32 v200, v40, v41
    v_cvt_pk_bf16_f32 v201, v42, v43
    v_cvt_pk_bf16_f32 v202, v44, v45
    v_cvt_pk_bf16_f32 v203, v46, v47
    s_waitcnt lgkmcnt(0)
    ds_read_b64_tr_b16 v[88:89], v5 offset:0
    ds_read_b64_tr_b16 v[92:93], v5 offset:32
    ds_read_b64_tr_b16 v[96:97], v5 offset:64
    ds_read_b64_tr_b16 v[100:101], v5 offset:96
    ds_read_b64_tr_b16 v[104:105], v5 offset:128
    ds_read_b64_tr_b16 v[108:109], v5 offset:160
    ds_read_b64_tr_b16 v[112:113], v5 offset:192
    ds_read_b64_tr_b16 v[116:117], v5 offset:224
    ds_read_b64_tr_b16 v[120:121], v5 offset:256
    v_exp_f32 v48, v48
    v_mfma_f32_16x16x32_bf16 v[52:55], v[124:127], v[200:203], v[52:55]
    v_exp_f32 v49, v49
    v_mfma_f32_16x16x32_bf16 v[56:59], v[128:131], v[200:203], v[56:59]
    v_exp_f32 v50, v50
    v_mfma_f32_16x16x32_bf16 v[60:63], v[132:135], v[200:203], v[60:63]
    v_exp_f32 v51, v51
    v_mfma_f32_16x16x32_bf16 v[64:67], v[136:139], v[200:203], v[64:67]
    v_pk_add_f32 v[48:49], v[48:49], 1.0 op_sel_hi:[1,0]
    v_mfma_f32_16x16x32_bf16 v[68:71], v[140:143], v[200:203], v[68:71]
    v_pk_add_f32 v[50:51], v[50:51], 1.0 op_sel_hi:[1,0]
    v_mfma_f32_16x16x32_bf16 v[72:75], v[144:147], v[200:203], v[72:75]
    v_rcp_f32 v48, v48
    v_mfma_f32_16x16x32_bf16 v[76:79], v[148:151], v[200:203], v[76:79]
    v_rcp_f32 v49, v49
    v_mfma_f32_16x16x32_bf16 v[80:83], v[152:155], v[200:203], v[80:83]
    v_rcp_f32 v50, v50
    v_mfma_f32_16x16x32_bf16 v[84:87], v[156:159], v[200:203], v[84:87]
    v_rcp_f32 v51, v51
    v_pk_fma_f32 v[48:49], v[48:49], s[46:47], 1.0 op_sel_hi:[1,1,0]
    v_pk_fma_f32 v[50:51], v[50:51], s[46:47], 1.0 op_sel_hi:[1,1,0]
    v_cvt_pk_bf16_f32 v196, v48, v49
    v_cvt_pk_bf16_f32 v197, v50, v51
    s_waitcnt lgkmcnt(0)
    s_nop 1
    v_mfma_f32_16x16x16_bf16 v[52:55], v[88:89], v[196:197], v[52:55]
    v_mfma_f32_16x16x16_bf16 v[56:59], v[92:93], v[196:197], v[56:59]
    v_mfma_f32_16x16x16_bf16 v[60:63], v[96:97], v[196:197], v[60:63]
    v_mfma_f32_16x16x16_bf16 v[64:67], v[100:101], v[196:197], v[64:67]
    v_mfma_f32_16x16x16_bf16 v[68:71], v[104:105], v[196:197], v[68:71]
    v_mfma_f32_16x16x16_bf16 v[72:75], v[108:109], v[196:197], v[72:75]
    v_mfma_f32_16x16x16_bf16 v[76:79], v[112:113], v[196:197], v[76:79]
    v_mfma_f32_16x16x16_bf16 v[80:83], v[116:117], v[196:197], v[80:83]
    v_mfma_f32_16x16x16_bf16 v[84:87], v[120:121], v[196:197], v[84:87]
    s_nop 1
    v_cvt_pk_bf16_f32 v160, v52, v53
    v_cvt_pk_bf16_f32 v161, v54, v55
    v_cvt_pk_bf16_f32 v162, v56, v57
    v_cvt_pk_bf16_f32 v163, v58, v59
    s_nop 1
    v_permlane16_swap_b32 v160, v162
    v_permlane16_swap_b32 v161, v163
    s_nop 1
    buffer_store_dwordx4 v[160:163], v8, s[72:75], 0 offen offset:0
    v_cvt_pk_bf16_f32 v164, v60, v61
    v_cvt_pk_bf16_f32 v165, v62, v63
    v_cvt_pk_bf16_f32 v166, v64, v65
    v_cvt_pk_bf16_f32 v167, v66, v67
    s_nop 1
    v_permlane16_swap_b32 v164, v166
    v_permlane16_swap_b32 v165, v167
    s_nop 1
    buffer_store_dwordx4 v[164:167], v8, s[72:75], 0 offen offset:64
    v_cvt_pk_bf16_f32 v168, v68, v69
    v_cvt_pk_bf16_f32 v169, v70, v71
    v_cvt_pk_bf16_f32 v170, v72, v73
    v_cvt_pk_bf16_f32 v171, v74, v75
    s_nop 1
    v_permlane16_swap_b32 v168, v170
    v_permlane16_swap_b32 v169, v171
    s_nop 1
    buffer_store_dwordx4 v[168:171], v8, s[72:75], 0 offen offset:128
    v_cvt_pk_bf16_f32 v172, v76, v77
    v_cvt_pk_bf16_f32 v173, v78, v79
    v_cvt_pk_bf16_f32 v174, v80, v81
    v_cvt_pk_bf16_f32 v175, v82, v83
    s_nop 1
    v_permlane16_swap_b32 v172, v174
    v_permlane16_swap_b32 v173, v175
    s_nop 1
    buffer_store_dwordx4 v[172:175], v8, s[72:75], 0 offen offset:192
    v_cvt_pk_bf16_f32 v176, v84, v85
    v_cvt_pk_bf16_f32 v177, v86, v87
    buffer_store_dwordx2 v[176:177], v9, s[72:75], 0 offen offset:256
    s_endpgm
L_ge:
    s_sub_u32 s30, s2, 250
    s_waitcnt lgkmcnt(0)
    s_load_dwordx2 s[4:5], s[0:1], 24
    s_load_dwordx2 s[6:7], s[0:1], 40
    s_mul_i32 s37, s30, 2304
    s_waitcnt lgkmcnt(0)
    s_add_u32 s8, s4, s37
    s_addc_u32 s9, s5, 0
    s_and_b32 s9, s9, 0xffff
    s_mov_b32 s10, 2304
    s_mov_b32 s11, 0x20000
    s_mov_b32 s12, s6
    s_and_b32 s13, s7, 0xffff
    s_mov_b32 s14, 41472
    s_mov_b32 s15, 0x20000
    s_mov_b32 s20, s26
    s_and_b32 s21, s27, 0xffff
    s_mov_b32 s22, 16777216
    s_mov_b32 s23, 0x20000
    s_mov_b32 s76, s46
    s_and_b32 s77, s47, 0xffff
    s_mov_b32 s78, 256
    s_mov_b32 s79, 0x20000
    s_sub_u32 s41, s32, 0
    s_lshl_b32 s40, s41, 6
    v_add_u32 v1, s40, v0
    s_lshl_b32 s41, s41, 10
    s_add_u32 s41, s41, 107520
    s_mov_b32 s42, 0
    s_movk_i32 s43, 3641
    s_cmp_eq_u32 s32, 0
    s_cselect_b32 s44, 6, 5
L_w144_wg:
    v_mul_u32_u24 v2, s43, v1
    v_lshrrev_b32 v2, 16, v2
    v_mul_u32_u24 v3, 18, v2
    v_sub_u32 v3, v1, v3
    v_and_b32 v4, 4, v2
    v_lshlrev_b32 v4, 1, v4
    v_and_b32 v5, 8, v2
    v_lshrrev_b32 v5, 1, v5
    v_or_b32 v4, v4, v5
    v_and_b32 v5, 0xf3, v2
    v_or_b32 v4, v4, v5
    s_mov_b32 m0, s41
    v_add_u32 v1, 512, v1
    v_mul_u32_u24 v4, 288, v4
    v_lshl_add_u32 v4, v3, 4, v4
    buffer_load_dwordx4 v4, s[12:15], 0 offen lds
    s_add_u32 s41, s41, 8192
    s_add_u32 s42, s42, 1
    s_cmp_lt_u32 s42, s44
    s_cbranch_scc1 L_w144_wg

    v_lshlrev_b32 v1, 4, v0
    s_lshl_b32 s39, s32, 10
    v_add_u32 v1, s39, v1
    s_add_u32 m0, s39, 0
    s_cmp_ge_u32 s32, 3
    s_cbranch_scc1 L_ge_skip
    buffer_load_dwordx4 v1, s[8:11], 0 offen lds
L_ge_skip:
    s_waitcnt vmcnt(0)
    s_barrier

    v_lshrrev_b32 v10, 5, v0
    v_lshlrev_b32 v10, 4, v10
    v_bfe_u32 v11, v0, 4, 1
    v_lshl_add_u32 v10, v11, 2, v10
    v_bfe_u32 v11, v0, 2, 2
    v_add_u32 v10, v10, v11
    v_mul_u32_u24 v10, 288, v10
    v_and_b32 v11, 3, v0
    v_lshl_add_u32 v4, v11, 3, v10

    v_bfe_u32 v10, v0, 4, 1
    v_lshlrev_b32 v10, 1, v10
    v_bfe_u32 v11, v0, 5, 1
    v_or_b32 v10, v10, v11
    v_bfe_u32 v11, v0, 2, 2
    v_lshl_add_u32 v10, v10, 2, v11
    v_add_u32 v10, 128, v10
    v_mul_u32_u24 v10, 288, v10
    v_and_b32 v11, 3, v0
    v_lshl_add_u32 v5, v11, 3, v10

    v_and_b32 v1, 15, v0
    v_lshrrev_b32 v2, 4, v0
    v_mul_u32_u24 v6, 288, v1
    v_add_u32 v6, 0, v6
    v_lshl_add_u32 v7, v2, 3, v6
    v_add_u32 v7, 256, v7
    v_lshl_add_u32 v6, v2, 4, v6
    s_lshl_b32 s39, s32, 5
    s_add_u32 s39, s39, 107520
    v_add_u32 v4, s39, v4
    v_add_u32 v5, s39, v5
    v_mul_u32_u24 v8, 576, v1
    v_lshl_add_u32 v8, v2, 4, v8
    s_mul_i32 s40, s30, 4608
    s_add_u32 s40, s40, 3145728
    s_lshl_b32 s41, s32, 6
    s_add_u32 s40, s40, s41
    v_add_u32 v8, s40, v8
    v_mov_b32 v9, 2147483648
    v_cmp_gt_u32 vcc, 8, v1
    s_mov_b32 s44, 1077455419

    v_cndmask_b32 v8, v9, v8, vcc
    ds_read_b128 v[64:67], v6 offset:0
    ds_read_b128 v[68:71], v6 offset:64
    ds_read_b128 v[72:75], v6 offset:128
    ds_read_b128 v[76:79], v6 offset:192
    ds_read_b64 v[80:81], v7
    ds_read_b64_tr_b16 v[84:85], v4 offset:0
    ds_read_b64_tr_b16 v[86:87], v4 offset:2304
    ds_read_b64_tr_b16 v[88:89], v4 offset:9216
    ds_read_b64_tr_b16 v[90:91], v4 offset:11520
    ds_read_b64_tr_b16 v[92:93], v4 offset:18432
    ds_read_b64_tr_b16 v[94:95], v4 offset:20736
    ds_read_b64_tr_b16 v[96:97], v4 offset:27648
    ds_read_b64_tr_b16 v[98:99], v4 offset:29952
    ds_read_b64_tr_b16 v[100:101], v5 offset:0
    s_waitcnt lgkmcnt(7)
    v_mfma_f32_16x16x32_bf16 v[32:35], v[84:87], v[64:67], 0
    s_waitcnt lgkmcnt(5)
    v_mfma_f32_16x16x32_bf16 v[32:35], v[88:91], v[68:71], v[32:35]
    s_waitcnt lgkmcnt(3)
    v_mfma_f32_16x16x32_bf16 v[32:35], v[92:95], v[72:75], v[32:35]
    s_waitcnt lgkmcnt(1)
    v_mfma_f32_16x16x32_bf16 v[32:35], v[96:99], v[76:79], v[32:35]
    s_waitcnt lgkmcnt(0)
    s_nop 7
    v_mfma_f32_16x16x16_bf16 v[32:35], v[100:101], v[80:81], v[32:35]
    s_nop 7
    v_mul_f32 v36, s44, v32
    v_mul_f32 v37, s44, v33
    v_mul_f32 v38, s44, v34
    v_mul_f32 v39, s44, v35
    buffer_store_dwordx4 v[36:39], v8, s[20:23], 0 offen offset:0 sc1
    s_nop 1
    s_cmp_lg_u32 s32, 0
    s_cbranch_scc1 L_ge_done
    ds_read_b64_tr_b16 v[84:85], v4 offset:256
    ds_read_b64_tr_b16 v[86:87], v4 offset:2560
    ds_read_b64_tr_b16 v[88:89], v4 offset:9472
    ds_read_b64_tr_b16 v[90:91], v4 offset:11776
    ds_read_b64_tr_b16 v[92:93], v4 offset:18688
    ds_read_b64_tr_b16 v[94:95], v4 offset:20992
    ds_read_b64_tr_b16 v[96:97], v4 offset:27904
    ds_read_b64_tr_b16 v[98:99], v4 offset:30208
    ds_read_b64_tr_b16 v[100:101], v5 offset:256
    s_waitcnt lgkmcnt(7)
    v_mfma_f32_16x16x32_bf16 v[32:35], v[84:87], v[64:67], 0
    s_waitcnt lgkmcnt(5)
    v_mfma_f32_16x16x32_bf16 v[32:35], v[88:91], v[68:71], v[32:35]
    s_waitcnt lgkmcnt(3)
    v_mfma_f32_16x16x32_bf16 v[32:35], v[92:95], v[72:75], v[32:35]
    s_waitcnt lgkmcnt(1)
    v_mfma_f32_16x16x32_bf16 v[32:35], v[96:99], v[76:79], v[32:35]
    s_waitcnt lgkmcnt(0)
    s_nop 7
    v_mfma_f32_16x16x16_bf16 v[32:35], v[100:101], v[80:81], v[32:35]
    s_nop 7
    v_mul_f32 v36, s44, v32
    v_mul_f32 v37, s44, v33
    v_mul_f32 v38, s44, v34
    v_mul_f32 v39, s44, v35
    buffer_store_dwordx4 v[36:39], v8, s[20:23], 0 offen offset:512 sc1
    s_nop 1
L_ge_done:
    s_waitcnt vmcnt(0)
    s_barrier
    s_cmp_lg_u32 s32, 0
    s_cbranch_scc1 L_k1_end
    s_add_u32 s39, s30, 50
    s_lshl_b32 s39, s39, 2
    v_mov_b32 v1, s39
    v_mov_b32 v2, 2147483648
    v_cmp_eq_u32 vcc, 0, v0
    v_mov_b32 v3, 1
    s_nop 0
    v_cndmask_b32 v1, v2, v1, vcc
    buffer_atomic_add v3, v1, s[76:79], 0 offen sc1

L_k1_end:
    s_endpgm
.section .rodata,"a"
.p2align 6
.amdhsa_kernel standalone__seq2seq_rnn_t_joint__speech_kernel
  .amdhsa_next_free_vgpr 208
  .amdhsa_next_free_sgpr 102
  .amdhsa_accum_offset 208
  .amdhsa_group_segment_fixed_size 0
  .amdhsa_kernarg_size 80
  .amdhsa_user_sgpr_count 2
  .amdhsa_user_sgpr_kernarg_segment_ptr 1
  .amdhsa_system_sgpr_workgroup_id_x 1
.end_amdhsa_kernel
```
